```python
import torch

def _softmax(x, axis=-1):
    return torch.softmax(x, dim=axis)
def _gelu(x):
    return torch.nn.functional.gelu(x, approximate="tanh")
def _silu(x):
    return torch.nn.functional.silu(x)
def _sigmoid(x):
    return torch.sigmoid(x)
def _layernorm(x, axis=-1, eps=1e-5):
    m = x.mean(dim=axis, keepdim=True)
    v = x.var(dim=axis, keepdim=True, unbiased=False)
    return (x - m) / torch.sqrt(v + eps)
def _scatter_add(tgt, idx, src, axis=0):
    return tgt.clone().index_add_(axis, idx, src)
def _segment_sum(src, seg, n):
    out = torch.zeros((n,) + src.shape[1:], dtype=src.dtype)
    return out.index_add_(0, seg, src)
def _pad(x, pw):
    flat = tuple(v for pair in reversed(pw) for v in pair)
    return torch.nn.functional.pad(x, flat)

kernel_name = 'parallel_sum__mha_block_cached__geglu_ffn__decode'

def setup_inputs():

    _w = (lambda a: (lambda t: t.to(torch.bfloat16) if t.is_floating_point() else t)(torch.as_tensor(a)))
    def _A_setup():
        B, Sq, D = 2, 1, 576
        H, Sk, Dh = 32, 8192, 128
        return {
            "x": _w((lambda *s: torch.randn(*s, dtype=torch.bfloat16) * 0.05)(B, Sq, D)),
            "k_cache": _w((lambda *s: torch.randn(*s, dtype=torch.bfloat16) * 3.2)(B, H, Sk, Dh)),
            "v_cache": _w((lambda *s: torch.randn(*s, dtype=torch.bfloat16) * 1.6)(B, H, Sk, Dh)),
            "wq": _w((lambda *s: torch.randn(*s, dtype=torch.bfloat16) * 3.2)(D, H * Dh) * (D ** -0.5)),
            "wo": _w((lambda *s: torch.randn(*s, dtype=torch.bfloat16) * 1.6)(H * Dh, D) * ((H * Dh) ** -0.5)),
        }
    _A_in = _A_setup()

    def _B_setup():
        B, S, D, F = 2, 1, 576, 4608
        return {
            "x": _w((lambda *s: torch.randn(*s, dtype=torch.bfloat16) * 0.05)(B, S, D)),
            "w_gate": _w((lambda *s: torch.randn(*s, dtype=torch.bfloat16) * 0.05)(D, F)),
            "w_up": _w((lambda *s: torch.randn(*s, dtype=torch.bfloat16) * 0.05)(D, F)),
            "w_down": _w((lambda *s: torch.randn(*s, dtype=torch.bfloat16) * 0.05)(F, D)),
        }
    _B_in = _B_setup()

    return {
        "A_x": _A_in["x"],
        "A_k_cache": _A_in["k_cache"],
        "A_v_cache": _A_in["v_cache"],
        "A_wq": _A_in["wq"],
        "A_wo": _A_in["wo"],
        "B_x": _B_in["x"],
        "B_w_gate": _B_in["w_gate"],
        "B_w_up": _B_in["w_up"],
        "B_w_down": _B_in["w_down"],
    }

def reference(A_x, A_k_cache, A_v_cache, A_wq, A_wo, B_x, B_w_gate, B_w_up, B_w_down):
    def _A_ref(x, k_cache, v_cache, wq, wo):
        B, Sq, D = x.shape
        H, Dh = 32, 128
        q = (lambda x, *d: x.permute(*d))((x @ wq).reshape(B, Sq, H, Dh), 0, 2, 1, 3)
        scores = torch.einsum("bhqd,bhkd->bhqk", q, k_cache) * (Dh ** -0.5)
        p = _softmax(scores, axis=-1)
        o = torch.einsum("bhqk,bhkd->bhqd", p, v_cache)
        return (lambda x, *d: x.permute(*d))(o, 0, 2, 1, 3).reshape(B, Sq, H * Dh) @ wo

    def _B_ref(x, w_gate, w_up, w_down):
        return (_gelu(x @ w_gate) * (x @ w_up)) @ w_down

    x = A_x
    xn = _layernorm(x, axis=-1)
    return x + _A_ref(xn, A_k_cache, A_v_cache, A_wq, A_wo) + _B_ref(xn, B_w_gate, B_w_up, B_w_down)
```

```asm
; @launch grid=(256,1,1) block=(512,1,1) lds=52864
.amdgcn_target "amdgcn-amd-amdhsa--gfx950"
.text
.globl parallel_sum__mha_block_cached__geglu_ffn__decode_kernel
.p2align 8
.type parallel_sum__mha_block_cached__geglu_ffn__decode_kernel,@function
parallel_sum__mha_block_cached__geglu_ffn__decode_kernel:
s_cmp_ge_u32 s2, 256
s_cbranch_scc1 L_end
s_load_dwordx16 s[4:19], s[0:1], 0
s_load_dwordx8 s[20:27], s[0:1], 64
v_lshrrev_b32 v1, 6, v0
v_and_b32 v0, 63, v0
s_nop 0
v_readfirstlane_b32 s64, v1
s_and_b32 s74, s2, 7
s_lshr_b32 s75, s2, 6
s_lshl_b32 s75, s75, 3
s_add_u32 s60, s74, s75
s_bfe_u32 s61, s2, 0x30003
s_lshr_b32 s62, s61, 2
s_and_b32 s63, s61, 3
s_lshl_b32 s68, s60, 3
s_add_u32 s68, s68, s61
s_cmp_eq_u32 s63, 3
s_cselect_b32 s3, 4, 0
s_sub_u32 s3, 129, s3
v_lshrrev_b32 v1, 4, v0
v_and_b32 v2, 15, v0
v_mov_b32 v18, 0
s_mov_b32 s79, 0x3fb8aa3b
s_waitcnt lgkmcnt(0)
s_mov_b32 s36, s26
s_mov_b32 s37, s27
s_mov_b32 s38, 1769472
s_mov_b32 s39, 0x20000
s_cmp_lt_u32 s64, 4
s_cbranch_scc1 L_attn
s_cmp_gt_u32 s64, 5
s_cbranch_scc1 L_idle
s_setprio 3
s_mov_b32 s48, s4
s_mov_b32 s49, s5
s_mov_b32 s50, 2304
s_mov_b32 s51, 0x20000
v_mul_u32_u24 v3, 36, v0
v_mov_b32 v20, 0
s_cmp_eq_u32 s64, 4
s_cbranch_scc0 L_noep
buffer_load_dword v20, v18, s[36:39], 0 offen sc1
L_noep:
buffer_load_dwordx4 v[8:11], v3, s[48:51], 0 offen
buffer_load_dwordx4 v[12:15], v3, s[48:51], 0 offen offset:16
buffer_load_dword v16, v3, s[48:51], 0 offen offset:32
v_lshrrev_b32 v6, 3, v2
v_lshl_add_u32 v6, v1, 1, v6
v_and_b32 v7, 7, v0
s_cmp_eq_u32 s64, 4
s_cbranch_scc0 L_w1
v_mul_u32_u24 v5, 147456, v6
v_lshl_add_u32 v5, v7, 4, v5
s_lshr_b32 s74, s61, 1
s_mul_i32 s74, s74, 1179648
s_lshl_b32 s75, s60, 8
s_add_u32 s74, s74, s75
s_and_b32 s75, s61, 1
s_lshl_b32 s75, s75, 7
s_add_u32 s74, s74, s75
s_add_u32 s44, s10, s74
s_addc_u32 s45, s11, 0
s_mov_b32 s46, 1171584
s_mov_b32 s47, 0x20000
s_mov_b32 s80, 0
buffer_load_dwordx4 v[64:67], v5, s[44:47], s80 offen nt
s_add_u32 s80, s80, 8192
buffer_load_dwordx4 v[68:71], v5, s[44:47], s80 offen nt
s_add_u32 s80, s80, 8192
buffer_load_dwordx4 v[72:75], v5, s[44:47], s80 offen nt
s_add_u32 s80, s80, 8192
buffer_load_dwordx4 v[76:79], v5, s[44:47], s80 offen nt
s_add_u32 s80, s80, 8192
buffer_load_dwordx4 v[80:83], v5, s[44:47], s80 offen nt
s_add_u32 s80, s80, 8192
buffer_load_dwordx4 v[84:87], v5, s[44:47], s80 offen nt
s_add_u32 s80, s80, 8192
buffer_load_dwordx4 v[88:91], v5, s[44:47], s80 offen nt
s_add_u32 s80, s80, 8192
buffer_load_dwordx4 v[92:95], v5, s[44:47], s80 offen nt
s_add_u32 s80, s80, 8192
buffer_load_dwordx4 v[96:99], v5, s[44:47], s80 offen nt
s_add_u32 s80, s80, 8192
buffer_load_dwordx4 v[100:103], v5, s[44:47], s80 offen nt
s_add_u32 s80, s80, 8192
buffer_load_dwordx4 v[104:107], v5, s[44:47], s80 offen nt
s_add_u32 s80, s80, 8192
buffer_load_dwordx4 v[108:111], v5, s[44:47], s80 offen nt
s_add_u32 s80, s80, 8192
buffer_load_dwordx4 v[112:115], v5, s[44:47], s80 offen nt
s_add_u32 s80, s80, 8192
buffer_load_dwordx4 v[116:119], v5, s[44:47], s80 offen nt
s_add_u32 s80, s80, 8192
buffer_load_dwordx4 v[120:123], v5, s[44:47], s80 offen nt
s_add_u32 s80, s80, 8192
buffer_load_dwordx4 v[124:127], v5, s[44:47], s80 offen nt
s_add_u32 s80, s80, 8192
buffer_load_dwordx4 v[128:131], v5, s[44:47], s80 offen nt
s_add_u32 s80, s80, 8192
buffer_load_dwordx4 v[132:135], v5, s[44:47], s80 offen nt
v_mov_b32 v6, 24
v_mov_b32 v7, 0
ds_write_b64 v18, v[6:7] offset:0
s_lshr_b32 s99, s61, 1
s_waitcnt lgkmcnt(0)
s_barrier
s_waitcnt vmcnt(18)
s_branch L_ln
L_w1:
v_mul_u32_u24 v5, 165888, v6
v_lshl_add_u32 v5, v7, 4, v5
s_mov_b32 s99, s68
s_barrier
s_lshr_b32 s74, s99, 2
s_lshl_b32 s74, s74, 7
s_and_b32 s75, s99, 3
s_mul_i32 s75, s75, 1327104
s_add_u32 s74, s74, s75
s_add_u32 s40, s16, s74
s_addc_u32 s41, s17, 0
s_mov_b32 s42, 1318016
s_mov_b32 s43, 0x20000
s_add_u32 s44, s18, s74
s_addc_u32 s45, s19, 0
s_mov_b32 s46, 1318016
s_mov_b32 s47, 0x20000
s_mov_b32 s80, 0
buffer_load_dwordx4 v[64:67], v5, s[40:43], s80 offen nt
buffer_load_dwordx4 v[68:71], v5, s[44:47], s80 offen nt
s_add_u32 s80, s80, 9216
buffer_load_dwordx4 v[72:75], v5, s[40:43], s80 offen nt
buffer_load_dwordx4 v[76:79], v5, s[44:47], s80 offen nt
s_add_u32 s80, s80, 9216
buffer_load_dwordx4 v[80:83], v5, s[40:43], s80 offen nt
buffer_load_dwordx4 v[84:87], v5, s[44:47], s80 offen nt
s_add_u32 s80, s80, 9216
buffer_load_dwordx4 v[88:91], v5, s[40:43], s80 offen nt
buffer_load_dwordx4 v[92:95], v5, s[44:47], s80 offen nt
s_add_u32 s80, s80, 9216
buffer_load_dwordx4 v[96:99], v5, s[40:43], s80 offen nt
buffer_load_dwordx4 v[100:103], v5, s[44:47], s80 offen nt
s_add_u32 s80, s80, 9216
buffer_load_dwordx4 v[104:107], v5, s[40:43], s80 offen nt
buffer_load_dwordx4 v[108:111], v5, s[44:47], s80 offen nt
s_add_u32 s80, s80, 9216
buffer_load_dwordx4 v[112:115], v5, s[40:43], s80 offen nt
buffer_load_dwordx4 v[116:119], v5, s[44:47], s80 offen nt
s_add_u32 s80, s80, 9216
buffer_load_dwordx4 v[120:123], v5, s[40:43], s80 offen nt
buffer_load_dwordx4 v[124:127], v5, s[44:47], s80 offen nt
s_add_u32 s80, s80, 9216
buffer_load_dwordx4 v[128:131], v5, s[40:43], s80 offen nt
buffer_load_dwordx4 v[132:135], v5, s[44:47], s80 offen nt
s_add_u32 s80, s80, 9216
buffer_load_dwordx4 v[136:139], v5, s[40:43], s80 offen nt
buffer_load_dwordx4 v[140:143], v5, s[44:47], s80 offen nt
s_add_u32 s80, s80, 9216
buffer_load_dwordx4 v[144:147], v5, s[40:43], s80 offen nt
buffer_load_dwordx4 v[148:151], v5, s[44:47], s80 offen nt
s_add_u32 s80, s80, 9216
buffer_load_dwordx4 v[152:155], v5, s[40:43], s80 offen nt
buffer_load_dwordx4 v[156:159], v5, s[44:47], s80 offen nt
s_add_u32 s80, s80, 9216
buffer_load_dwordx4 v[160:163], v5, s[40:43], s80 offen nt
buffer_load_dwordx4 v[164:167], v5, s[44:47], s80 offen nt
s_add_u32 s80, s80, 9216
buffer_load_dwordx4 v[168:171], v5, s[40:43], s80 offen nt
buffer_load_dwordx4 v[172:175], v5, s[44:47], s80 offen nt
s_add_u32 s80, s80, 9216
buffer_load_dwordx4 v[176:179], v5, s[40:43], s80 offen nt
buffer_load_dwordx4 v[180:183], v5, s[44:47], s80 offen nt
s_add_u32 s80, s80, 9216
buffer_load_dwordx4 v[184:187], v5, s[40:43], s80 offen nt
buffer_load_dwordx4 v[188:191], v5, s[44:47], s80 offen nt
s_add_u32 s80, s80, 9216
buffer_load_dwordx4 v[192:195], v5, s[40:43], s80 offen nt
buffer_load_dwordx4 v[196:199], v5, s[44:47], s80 offen nt
s_add_u32 s80, s80, 9216
buffer_load_dwordx4 v[200:203], v5, s[40:43], s80 offen nt
buffer_load_dwordx4 v[204:207], v5, s[44:47], s80 offen nt
s_waitcnt vmcnt(36)
L_ln:
v_add_u32 v19, 0x01010101, v20
v_lshlrev_b32 v22, 16, v8
v_and_b32 v23, 0xffff0000, v8
v_lshlrev_b32 v24, 16, v9
v_and_b32 v25, 0xffff0000, v9
v_lshlrev_b32 v26, 16, v10
v_and_b32 v27, 0xffff0000, v10
v_lshlrev_b32 v28, 16, v11
v_and_b32 v29, 0xffff0000, v11
v_lshlrev_b32 v30, 16, v12
v_and_b32 v31, 0xffff0000, v12
v_lshlrev_b32 v32, 16, v13
v_and_b32 v33, 0xffff0000, v13
v_lshlrev_b32 v34, 16, v14
v_and_b32 v35, 0xffff0000, v14
v_lshlrev_b32 v36, 16, v15
v_and_b32 v37, 0xffff0000, v15
v_lshlrev_b32 v38, 16, v16
v_and_b32 v39, 0xffff0000, v16
v_readfirstlane_b32 s66, v19
v_add_f32 v46, v22, v23
v_add_f32 v47, v24, v25
v_add_f32 v46, v46, v26
v_add_f32 v47, v47, v27
v_add_f32 v46, v46, v28
v_add_f32 v47, v47, v29
v_add_f32 v46, v46, v30
v_add_f32 v47, v47, v31
v_add_f32 v46, v46, v32
v_add_f32 v47, v47, v33
v_add_f32 v46, v46, v34
v_add_f32 v47, v47, v35
v_add_f32 v46, v46, v36
v_add_f32 v47, v47, v37
v_add_f32 v46, v46, v38
v_add_f32 v47, v47, v39
v_add_f32 v46, v46, v47
s_nop 1
v_add_f32_dpp v46, v46, v46 row_ror:8 row_mask:0xf bank_mask:0xf
s_nop 1
v_add_f32_dpp v46, v46, v46 row_ror:4 row_mask:0xf bank_mask:0xf
s_nop 1
v_add_f32_dpp v46, v46, v46 row_ror:2 row_mask:0xf bank_mask:0xf
s_nop 1
v_add_f32_dpp v46, v46, v46 row_ror:1 row_mask:0xf bank_mask:0xf
v_mov_b32 v47, v46
s_nop 1
v_permlane16_swap_b32 v46, v47
v_add_f32 v46, v46, v47
v_mul_f32 v46, 0x3ae38e39, v46
v_sub_f32 v48, v22, v46
v_sub_f32 v49, v23, v46
v_mul_f32 v50, v48, v48
v_mul_f32 v51, v49, v49
v_sub_f32 v48, v24, v46
v_sub_f32 v49, v25, v46
v_fmac_f32 v50, v48, v48
v_fmac_f32 v51, v49, v49
v_sub_f32 v48, v26, v46
v_sub_f32 v49, v27, v46
v_fmac_f32 v50, v48, v48
v_fmac_f32 v51, v49, v49
v_sub_f32 v48, v28, v46
v_sub_f32 v49, v29, v46
v_fmac_f32 v50, v48, v48
v_fmac_f32 v51, v49, v49
v_sub_f32 v48, v30, v46
v_sub_f32 v49, v31, v46
v_fmac_f32 v50, v48, v48
v_fmac_f32 v51, v49, v49
v_sub_f32 v48, v32, v46
v_sub_f32 v49, v33, v46
v_fmac_f32 v50, v48, v48
v_fmac_f32 v51, v49, v49
v_sub_f32 v48, v34, v46
v_sub_f32 v49, v35, v46
v_fmac_f32 v50, v48, v48
v_fmac_f32 v51, v49, v49
v_sub_f32 v48, v36, v46
v_sub_f32 v49, v37, v46
v_fmac_f32 v50, v48, v48
v_fmac_f32 v51, v49, v49
v_sub_f32 v48, v38, v46
v_sub_f32 v49, v39, v46
v_fmac_f32 v50, v48, v48
v_fmac_f32 v51, v49, v49
v_add_f32 v50, v50, v51
s_nop 1
v_add_f32_dpp v50, v50, v50 row_ror:8 row_mask:0xf bank_mask:0xf
s_nop 1
v_add_f32_dpp v50, v50, v50 row_ror:4 row_mask:0xf bank_mask:0xf
s_nop 1
v_add_f32_dpp v50, v50, v50 row_ror:2 row_mask:0xf bank_mask:0xf
s_nop 1
v_add_f32_dpp v50, v50, v50 row_ror:1 row_mask:0xf bank_mask:0xf
v_mov_b32 v51, v50
s_nop 1
v_permlane16_swap_b32 v50, v51
v_add_f32 v50, v50, v51
v_mul_f32 v50, 0x3ae38e39, v50
v_cvt_pk_bf16_f32 v47, v46, v50
v_lshlrev_b32 v46, 16, v47
v_and_b32 v50, 0xffff0000, v47
v_add_f32 v50, 0x3727c5ac, v50
v_cvt_pk_bf16_f32 v50, v50, v50
v_lshlrev_b32 v50, 16, v50
v_sqrt_f32 v50, v50
s_nop 0
v_cvt_pk_bf16_f32 v50, v50, v50
v_lshlrev_b32 v50, 16, v50
v_rcp_f32 v51, v50
s_nop 0
v_fma_f32 v52, -v50, v51, 1.0
v_fmac_f32 v51, v52, v51
v_mul_u32_u24 v6, 72, v0
v_sub_f32 v22, v22, v46
v_sub_f32 v23, v23, v46
v_cvt_pk_bf16_f32 v48, v22, v23
v_lshlrev_b32 v22, 16, v48
v_and_b32 v23, 0xffff0000, v48
v_mul_f32 v22, v22, v51
v_mul_f32 v23, v23, v51
v_cvt_pk_bf16_f32 v22, v22, v22
v_cvt_pk_bf16_f32 v23, v23, v23
ds_write_b64 v6, v[22:23] offset:512
v_sub_f32 v24, v24, v46
v_sub_f32 v25, v25, v46
v_cvt_pk_bf16_f32 v48, v24, v25
v_lshlrev_b32 v24, 16, v48
v_and_b32 v25, 0xffff0000, v48
v_mul_f32 v24, v24, v51
v_mul_f32 v25, v25, v51
v_cvt_pk_bf16_f32 v24, v24, v24
v_cvt_pk_bf16_f32 v25, v25, v25
ds_write_b64 v6, v[24:25] offset:520
v_sub_f32 v26, v26, v46
v_sub_f32 v27, v27, v46
v_cvt_pk_bf16_f32 v48, v26, v27
v_lshlrev_b32 v26, 16, v48
v_and_b32 v27, 0xffff0000, v48
v_mul_f32 v26, v26, v51
v_mul_f32 v27, v27, v51
v_cvt_pk_bf16_f32 v26, v26, v26
v_cvt_pk_bf16_f32 v27, v27, v27
ds_write_b64 v6, v[26:27] offset:528
v_sub_f32 v28, v28, v46
v_sub_f32 v29, v29, v46
v_cvt_pk_bf16_f32 v48, v28, v29
v_lshlrev_b32 v28, 16, v48
v_and_b32 v29, 0xffff0000, v48
v_mul_f32 v28, v28, v51
v_mul_f32 v29, v29, v51
v_cvt_pk_bf16_f32 v28, v28, v28
v_cvt_pk_bf16_f32 v29, v29, v29
ds_write_b64 v6, v[28:29] offset:536
v_sub_f32 v30, v30, v46
v_sub_f32 v31, v31, v46
v_cvt_pk_bf16_f32 v48, v30, v31
v_lshlrev_b32 v30, 16, v48
v_and_b32 v31, 0xffff0000, v48
v_mul_f32 v30, v30, v51
v_mul_f32 v31, v31, v51
v_cvt_pk_bf16_f32 v30, v30, v30
v_cvt_pk_bf16_f32 v31, v31, v31
ds_write_b64 v6, v[30:31] offset:544
v_sub_f32 v32, v32, v46
v_sub_f32 v33, v33, v46
v_cvt_pk_bf16_f32 v48, v32, v33
v_lshlrev_b32 v32, 16, v48
v_and_b32 v33, 0xffff0000, v48
v_mul_f32 v32, v32, v51
v_mul_f32 v33, v33, v51
v_cvt_pk_bf16_f32 v32, v32, v32
v_cvt_pk_bf16_f32 v33, v33, v33
ds_write_b64 v6, v[32:33] offset:552
v_sub_f32 v34, v34, v46
v_sub_f32 v35, v35, v46
v_cvt_pk_bf16_f32 v48, v34, v35
v_lshlrev_b32 v34, 16, v48
v_and_b32 v35, 0xffff0000, v48
v_mul_f32 v34, v34, v51
v_mul_f32 v35, v35, v51
v_cvt_pk_bf16_f32 v34, v34, v34
v_cvt_pk_bf16_f32 v35, v35, v35
ds_write_b64 v6, v[34:35] offset:560
v_sub_f32 v36, v36, v46
v_sub_f32 v37, v37, v46
v_cvt_pk_bf16_f32 v48, v36, v37
v_lshlrev_b32 v36, 16, v48
v_and_b32 v37, 0xffff0000, v48
v_mul_f32 v36, v36, v51
v_mul_f32 v37, v37, v51
v_cvt_pk_bf16_f32 v36, v36, v36
v_cvt_pk_bf16_f32 v37, v37, v37
ds_write_b64 v6, v[36:37] offset:568
v_sub_f32 v38, v38, v46
v_sub_f32 v39, v39, v46
v_cvt_pk_bf16_f32 v48, v38, v39
v_lshlrev_b32 v38, 16, v48
v_and_b32 v39, 0xffff0000, v48
v_mul_f32 v38, v38, v51
v_mul_f32 v39, v39, v51
v_cvt_pk_bf16_f32 v38, v38, v38
v_cvt_pk_bf16_f32 v39, v39, v39
ds_write_b64 v6, v[38:39] offset:576
v_and_b32 v6, 1, v0
v_lshlrev_b32 v6, 4, v6
v_mov_b32 v7, 0xffff
v_lshlrev_b32 v7, v6, v7
v_bfe_u32 v6, v0, 1, 1
v_cmp_eq_u32 vcc, 0, v6
s_nop 1
v_cndmask_b32 v8, 0, v7, vcc
v_cmp_eq_u32 vcc, 1, v6
s_nop 1
v_cndmask_b32 v9, 0, v7, vcc
v_mov_b32 v3, 0xff
v_lshrrev_b32 v6, 3, v2
v_lshl_add_u32 v6, v1, 1, v6
v_mul_u32_u24 v10, 72, v6
v_bfe_u32 v7, v0, 2, 1
s_movk_i32 s76, 2304
v_mad_u32_u24 v10, v7, s76, v10
v_lshrrev_b32 v11, 3, v2
v_lshlrev_b32 v11, 9, v11
v_lshl_add_u32 v11, v7, 8, v11
v_and_b32 v7, 1, v1
v_lshl_add_u32 v11, v7, 7, v11
v_and_b32 v7, 3, v0
v_lshl_add_u32 v11, v7, 2, v11
v_lshlrev_b32 v12, 3, v0
v_lshlrev_b32 v13, 4, v0
s_waitcnt lgkmcnt(0)
s_cmp_eq_u32 s64, 4
s_cbranch_scc0 L_piece
s_and_b32 s75, s99, 3
s_mul_i32 s75, s75, 576
v_add_u32 v6, s75, v10
ds_read_b64 v[22:23], v6 offset:512
ds_read_b64 v[24:25], v6 offset:520
ds_read_b64 v[26:27], v6 offset:528
ds_read_b64 v[28:29], v6 offset:536
ds_read_b64 v[30:31], v6 offset:544
ds_read_b64 v[32:33], v6 offset:552
ds_read_b64 v[34:35], v6 offset:560
ds_read_b64 v[36:37], v6 offset:568
ds_read_b64 v[38:39], v6 offset:576
ds_write_b32 v18, v19 offset:8
v_and_b32 v7, 1, v0
v_lshlrev_b32 v7, 4, v7
v_lshrrev_b32 v14, v7, v19
v_lshrrev_b32 v15, 8, v14
s_lshl_b32 s74, s68, 10
s_add_u32 s74, s74, 1245184
s_add_u32 s80, s74, 262144
s_getreg_b32 s78, hwreg(HW_REG_XCC_ID)
s_and_b32 s78, s78, 15
s_lshl_b32 s78, s78, 8
v_mov_b32 v17, s78
v_lshrrev_b32 v52, 0, v19
v_bfi_b32 v52, v3, v52, v17
v_lshrrev_b32 v53, 8, v19
v_bfi_b32 v53, v3, v53, v17
v_lshrrev_b32 v54, 16, v19
v_bfi_b32 v54, v3, v54, v17
v_lshrrev_b32 v55, 24, v19
v_bfi_b32 v55, v3, v55, v17
v_not_b32 v44, v14
v_not_b32 v45, v15
buffer_store_dwordx2 v[44:45], v12, s[36:39], s80 offen
s_mov_b64 exec, 0xff
buffer_store_dwordx4 v[52:55], v13, s[36:39], s80 offen offset:512
s_mov_b64 exec, -1
s_waitcnt lgkmcnt(0)
v_and_b32 v48, v22, v8
v_and_b32 v49, v22, v9
s_waitcnt vmcnt(19)
s_nop 0
v_mfma_f32_16x16x16_bf16 v[208:211], v[64:65], v[48:49], 0
v_mfma_f32_16x16x16_bf16 v[212:215], v[66:67], v[48:49], 0
v_and_b32 v50, v23, v8
v_and_b32 v51, v23, v9
s_waitcnt vmcnt(18)
s_nop 0
v_mfma_f32_16x16x16_bf16 v[208:211], v[68:69], v[50:51], v[208:211]
v_mfma_f32_16x16x16_bf16 v[212:215], v[70:71], v[50:51], v[212:215]
v_and_b32 v48, v24, v8
v_and_b32 v49, v24, v9
s_waitcnt vmcnt(17)
s_nop 0
v_mfma_f32_16x16x16_bf16 v[208:211], v[72:73], v[48:49], v[208:211]
v_mfma_f32_16x16x16_bf16 v[212:215], v[74:75], v[48:49], v[212:215]
v_and_b32 v50, v25, v8
v_and_b32 v51, v25, v9
s_waitcnt vmcnt(16)
s_nop 0
v_mfma_f32_16x16x16_bf16 v[208:211], v[76:77], v[50:51], v[208:211]
v_mfma_f32_16x16x16_bf16 v[212:215], v[78:79], v[50:51], v[212:215]
v_and_b32 v48, v26, v8
v_and_b32 v49, v26, v9
s_waitcnt vmcnt(15)
s_nop 0
v_mfma_f32_16x16x16_bf16 v[208:211], v[80:81], v[48:49], v[208:211]
v_mfma_f32_16x16x16_bf16 v[212:215], v[82:83], v[48:49], v[212:215]
v_and_b32 v50, v27, v8
v_and_b32 v51, v27, v9
s_waitcnt vmcnt(14)
s_nop 0
v_mfma_f32_16x16x16_bf16 v[208:211], v[84:85], v[50:51], v[208:211]
v_mfma_f32_16x16x16_bf16 v[212:215], v[86:87], v[50:51], v[212:215]
v_and_b32 v48, v28, v8
v_and_b32 v49, v28, v9
s_waitcnt vmcnt(13)
s_nop 0
v_mfma_f32_16x16x16_bf16 v[208:211], v[88:89], v[48:49], v[208:211]
v_mfma_f32_16x16x16_bf16 v[212:215], v[90:91], v[48:49], v[212:215]
v_and_b32 v50, v29, v8
v_and_b32 v51, v29, v9
s_waitcnt vmcnt(12)
s_nop 0
v_mfma_f32_16x16x16_bf16 v[208:211], v[92:93], v[50:51], v[208:211]
v_mfma_f32_16x16x16_bf16 v[212:215], v[94:95], v[50:51], v[212:215]
v_and_b32 v48, v30, v8
v_and_b32 v49, v30, v9
s_waitcnt vmcnt(11)
s_nop 0
v_mfma_f32_16x16x16_bf16 v[208:211], v[96:97], v[48:49], v[208:211]
v_mfma_f32_16x16x16_bf16 v[212:215], v[98:99], v[48:49], v[212:215]
v_and_b32 v50, v31, v8
v_and_b32 v51, v31, v9
s_waitcnt vmcnt(10)
s_nop 0
v_mfma_f32_16x16x16_bf16 v[208:211], v[100:101], v[50:51], v[208:211]
v_mfma_f32_16x16x16_bf16 v[212:215], v[102:103], v[50:51], v[212:215]
v_and_b32 v48, v32, v8
v_and_b32 v49, v32, v9
s_waitcnt vmcnt(9)
s_nop 0
v_mfma_f32_16x16x16_bf16 v[208:211], v[104:105], v[48:49], v[208:211]
v_mfma_f32_16x16x16_bf16 v[212:215], v[106:107], v[48:49], v[212:215]
v_and_b32 v50, v33, v8
v_and_b32 v51, v33, v9
s_waitcnt vmcnt(8)
s_nop 0
v_mfma_f32_16x16x16_bf16 v[208:211], v[108:109], v[50:51], v[208:211]
v_mfma_f32_16x16x16_bf16 v[212:215], v[110:111], v[50:51], v[212:215]
v_and_b32 v48, v34, v8
v_and_b32 v49, v34, v9
s_waitcnt vmcnt(7)
s_nop 0
v_mfma_f32_16x16x16_bf16 v[208:211], v[112:113], v[48:49], v[208:211]
v_mfma_f32_16x16x16_bf16 v[212:215], v[114:115], v[48:49], v[212:215]
v_and_b32 v50, v35, v8
v_and_b32 v51, v35, v9
s_waitcnt vmcnt(6)
s_nop 0
v_mfma_f32_16x16x16_bf16 v[208:211], v[116:117], v[50:51], v[208:211]
v_mfma_f32_16x16x16_bf16 v[212:215], v[118:119], v[50:51], v[212:215]
v_and_b32 v48, v36, v8
v_and_b32 v49, v36, v9
s_waitcnt vmcnt(5)
s_nop 0
v_mfma_f32_16x16x16_bf16 v[208:211], v[120:121], v[48:49], v[208:211]
v_mfma_f32_16x16x16_bf16 v[212:215], v[122:123], v[48:49], v[212:215]
v_and_b32 v50, v37, v8
v_and_b32 v51, v37, v9
s_waitcnt vmcnt(4)
s_nop 0
v_mfma_f32_16x16x16_bf16 v[208:211], v[124:125], v[50:51], v[208:211]
v_mfma_f32_16x16x16_bf16 v[212:215], v[126:127], v[50:51], v[212:215]
v_and_b32 v48, v38, v8
v_and_b32 v49, v38, v9
s_waitcnt vmcnt(3)
s_nop 0
v_mfma_f32_16x16x16_bf16 v[208:211], v[128:129], v[48:49], v[208:211]
v_mfma_f32_16x16x16_bf16 v[212:215], v[130:131], v[48:49], v[212:215]
v_and_b32 v50, v39, v8
v_and_b32 v51, v39, v9
s_waitcnt vmcnt(2)
s_nop 0
v_mfma_f32_16x16x16_bf16 v[208:211], v[132:133], v[50:51], v[208:211]
v_mfma_f32_16x16x16_bf16 v[212:215], v[134:135], v[50:51], v[212:215]
v_lshrrev_b32 v6, 5, v0
v_mul_u32_u24 v6, 768, v6
v_add_u32 v6, v6, v12
s_lshl_b32 s96, s60, 13
s_add_u32 s96, s96, 1245184
s_lshl_b32 s97, s62, 8
v_lshrrev_b32 v16, 3, v0
v_lshlrev_b32 v16, 10, v16
v_and_b32 v17, 7, v0
v_lshl_add_u32 v16, v17, 4, v16
s_mov_b32 exec_lo, 0x00ff00ff
s_mov_b32 exec_hi, 0xff00ff00
ds_write_b32 v11, v208 offset:7168
ds_write_b32 v11, v209 offset:7200
ds_write_b32 v11, v210 offset:7232
ds_write_b32 v11, v211 offset:7264
ds_write_b32 v11, v212 offset:7184
ds_write_b32 v11, v213 offset:7216
ds_write_b32 v11, v214 offset:7248
ds_write_b32 v11, v215 offset:7280
s_mov_b64 exec, -1
s_waitcnt lgkmcnt(0)
ds_read_b64 v[44:45], v12 offset:7168
ds_read_b64 v[46:47], v12 offset:7680
s_mov_b32 s69, 40000
s_waitcnt lgkmcnt(0)
v_add_f32 v44, v44, v46
v_add_f32 v45, v45, v47
v_add_u32 v44, 0x80, v44
v_add_u32 v45, 0x80, v45
v_bfi_b32 v44, v3, v14, v44
v_bfi_b32 v45, v3, v15, v45
buffer_store_dwordx2 v[44:45], v12, s[36:39], s80 offen
s_mov_b32 s71, s74
s_mov_b32 s72, 0
s_mov_b32 s98, 262144
L_qpoll:
s_add_u32 s77, s96, s98
s_add_u32 s75, s77, s97
s_add_u32 s76, s75, 4096
s_xor_b32 s74, s98, 262144
s_cmp_lt_u32 s69, 39993
s_cselect_b32 s98, s74, s98
s_cmp_eq_u32 s69, 39992
s_cbranch_scc0 L_qnob
buffer_store_dwordx2 v[44:45], v12, s[36:39], s71 offen sc1
s_mov_b64 exec, 0xff
buffer_store_dwordx4 v[52:55], v13, s[36:39], s71 offen offset:512 sc1
s_mov_b64 exec, -1
s_mov_b32 s72, 1
L_qnob:
s_cmp_lg_u32 s77, s96
s_cselect_b32 s73, 1, 0
s_cmp_eq_u32 s73, 1
s_cbranch_scc1 L_lp626f
buffer_load_dwordx2 v[64:65], v6, s[36:39], s75 offen offset:0 sc1
buffer_load_dwordx2 v[66:67], v6, s[36:39], s75 offen offset:2048 sc1
buffer_load_dwordx2 v[68:69], v6, s[36:39], s76 offen offset:0 sc1
buffer_load_dwordx2 v[70:71], v6, s[36:39], s76 offen offset:2048 sc1
buffer_load_dwordx4 v[72:75], v16, s[36:39], s77 offen offset:512 sc1
s_branch L_lp626e
L_lp626f:
buffer_load_dwordx2 v[64:65], v6, s[36:39], s75 offen offset:0 nt
buffer_load_dwordx2 v[66:67], v6, s[36:39], s75 offen offset:2048 nt
buffer_load_dwordx2 v[68:69], v6, s[36:39], s76 offen offset:0 nt
buffer_load_dwordx2 v[70:71], v6, s[36:39], s76 offen offset:2048 nt
buffer_load_dwordx4 v[72:75], v16, s[36:39], s77 offen offset:512 nt
L_lp626e:
s_waitcnt vmcnt(0)
v_xor_b32 v7, v14, v64
v_xor_b32 v46, v15, v65
v_or_b32 v7, v7, v46
v_xor_b32 v46, v14, v66
v_or_b32 v7, v7, v46
v_xor_b32 v46, v15, v67
v_or_b32 v7, v7, v46
v_xor_b32 v46, v14, v68
v_or_b32 v7, v7, v46
v_xor_b32 v46, v15, v69
v_or_b32 v7, v7, v46
v_xor_b32 v46, v14, v70
v_or_b32 v7, v7, v46
v_xor_b32 v46, v15, v71
v_or_b32 v7, v7, v46
v_xor_b32 v46, v52, v72
v_or_b32 v7, v7, v46
v_xor_b32 v46, v53, v73
v_or_b32 v7, v7, v46
v_xor_b32 v46, v54, v74
v_or_b32 v7, v7, v46
v_xor_b32 v46, v55, v75
v_or_b32 v7, v7, v46
v_and_b32 v7, 0xff, v7
v_cmp_ne_u32 vcc, 0, v7
s_cbranch_vccz L_qpolld
s_sub_u32 s69, s69, 1
s_cmp_eq_u32 s69, 0
s_cbranch_scc0 L_qpoll
L_qpolld:
v_cmp_ne_u32 vcc, v52, v72
v_mov_b32 v7, 0xffffff00
s_cmp_eq_u64 vcc, 0
s_cselect_b32 s67, 1, 0
v_mov_b32 v46, s67
ds_write_b32 v18, v46 offset:12
v_and_b32 v64, v7, v64
v_and_b32 v65, v7, v65
v_and_b32 v66, v7, v66
v_and_b32 v67, v7, v67
v_and_b32 v68, v7, v68
v_and_b32 v69, v7, v69
v_and_b32 v70, v7, v70
v_and_b32 v71, v7, v71
v_add_f32 v64, v64, v66
v_add_f32 v68, v68, v70
v_add_f32 v64, v64, v68
v_add_f32 v65, v65, v67
v_add_f32 v69, v69, v71
v_add_f32 v65, v65, v69
v_cvt_pk_bf16_f32 v7, v64, v65
v_lshlrev_b32 v6, 2, v0
ds_write_b32 v6, v7 offset:64
v_mov_b32 v6, 1
s_waitcnt lgkmcnt(0)
ds_write_b32 v18, v6 offset:4
s_or_b32 s74, s67, s72
s_cmp_eq_u32 s74, 0
s_cbranch_scc0 L_qnob2
buffer_store_dwordx2 v[44:45], v12, s[36:39], s71 offen sc1
s_mov_b64 exec, 0xff
buffer_store_dwordx4 v[52:55], v13, s[36:39], s71 offen offset:512 sc1
s_mov_b64 exec, -1
s_mov_b32 s72, 1
L_qnob2:
s_branch L_idle2
L_piece:
s_and_b32 s75, s99, 3
s_mul_i32 s75, s75, 576
v_add_u32 v6, s75, v10
ds_read_b64 v[22:23], v6 offset:512
ds_read_b64 v[24:25], v6 offset:520
ds_read_b64 v[26:27], v6 offset:528
ds_read_b64 v[28:29], v6 offset:536
ds_read_b64 v[30:31], v6 offset:544
ds_read_b64 v[32:33], v6 offset:552
ds_read_b64 v[34:35], v6 offset:560
ds_read_b64 v[36:37], v6 offset:568
ds_read_b64 v[38:39], v6 offset:576
s_waitcnt lgkmcnt(0)
v_and_b32 v48, v22, v8
v_and_b32 v49, v22, v9
s_waitcnt vmcnt(34)
s_nop 0
v_mfma_f32_16x16x16_bf16 v[208:211], v[64:65], v[48:49], 0
v_mfma_f32_16x16x16_bf16 v[212:215], v[66:67], v[48:49], 0
v_mfma_f32_16x16x16_bf16 v[216:219], v[68:69], v[48:49], 0
v_mfma_f32_16x16x16_bf16 v[220:223], v[70:71], v[48:49], 0
v_and_b32 v50, v23, v8
v_and_b32 v51, v23, v9
s_waitcnt vmcnt(32)
s_nop 0
v_mfma_f32_16x16x16_bf16 v[208:211], v[72:73], v[50:51], v[208:211]
v_mfma_f32_16x16x16_bf16 v[212:215], v[74:75], v[50:51], v[212:215]
v_mfma_f32_16x16x16_bf16 v[216:219], v[76:77], v[50:51], v[216:219]
v_mfma_f32_16x16x16_bf16 v[220:223], v[78:79], v[50:51], v[220:223]
v_and_b32 v48, v24, v8
v_and_b32 v49, v24, v9
s_waitcnt vmcnt(30)
s_nop 0
v_mfma_f32_16x16x16_bf16 v[208:211], v[80:81], v[48:49], v[208:211]
v_mfma_f32_16x16x16_bf16 v[212:215], v[82:83], v[48:49], v[212:215]
v_mfma_f32_16x16x16_bf16 v[216:219], v[84:85], v[48:49], v[216:219]
v_mfma_f32_16x16x16_bf16 v[220:223], v[86:87], v[48:49], v[220:223]
v_and_b32 v50, v25, v8
v_and_b32 v51, v25, v9
s_waitcnt vmcnt(28)
s_nop 0
v_mfma_f32_16x16x16_bf16 v[208:211], v[88:89], v[50:51], v[208:211]
v_mfma_f32_16x16x16_bf16 v[212:215], v[90:91], v[50:51], v[212:215]
v_mfma_f32_16x16x16_bf16 v[216:219], v[92:93], v[50:51], v[216:219]
v_mfma_f32_16x16x16_bf16 v[220:223], v[94:95], v[50:51], v[220:223]
v_and_b32 v48, v26, v8
v_and_b32 v49, v26, v9
s_waitcnt vmcnt(26)
s_nop 0
v_mfma_f32_16x16x16_bf16 v[208:211], v[96:97], v[48:49], v[208:211]
v_mfma_f32_16x16x16_bf16 v[212:215], v[98:99], v[48:49], v[212:215]
v_mfma_f32_16x16x16_bf16 v[216:219], v[100:101], v[48:49], v[216:219]
v_mfma_f32_16x16x16_bf16 v[220:223], v[102:103], v[48:49], v[220:223]
v_and_b32 v50, v27, v8
v_and_b32 v51, v27, v9
s_waitcnt vmcnt(24)
s_nop 0
v_mfma_f32_16x16x16_bf16 v[208:211], v[104:105], v[50:51], v[208:211]
v_mfma_f32_16x16x16_bf16 v[212:215], v[106:107], v[50:51], v[212:215]
v_mfma_f32_16x16x16_bf16 v[216:219], v[108:109], v[50:51], v[216:219]
v_mfma_f32_16x16x16_bf16 v[220:223], v[110:111], v[50:51], v[220:223]
v_and_b32 v48, v28, v8
v_and_b32 v49, v28, v9
s_waitcnt vmcnt(22)
s_nop 0
v_mfma_f32_16x16x16_bf16 v[208:211], v[112:113], v[48:49], v[208:211]
v_mfma_f32_16x16x16_bf16 v[212:215], v[114:115], v[48:49], v[212:215]
v_mfma_f32_16x16x16_bf16 v[216:219], v[116:117], v[48:49], v[216:219]
v_mfma_f32_16x16x16_bf16 v[220:223], v[118:119], v[48:49], v[220:223]
v_and_b32 v50, v29, v8
v_and_b32 v51, v29, v9
s_waitcnt vmcnt(20)
s_nop 0
v_mfma_f32_16x16x16_bf16 v[208:211], v[120:121], v[50:51], v[208:211]
v_mfma_f32_16x16x16_bf16 v[212:215], v[122:123], v[50:51], v[212:215]
v_mfma_f32_16x16x16_bf16 v[216:219], v[124:125], v[50:51], v[216:219]
v_mfma_f32_16x16x16_bf16 v[220:223], v[126:127], v[50:51], v[220:223]
v_and_b32 v48, v30, v8
v_and_b32 v49, v30, v9
s_waitcnt vmcnt(18)
s_nop 0
v_mfma_f32_16x16x16_bf16 v[208:211], v[128:129], v[48:49], v[208:211]
v_mfma_f32_16x16x16_bf16 v[212:215], v[130:131], v[48:49], v[212:215]
v_mfma_f32_16x16x16_bf16 v[216:219], v[132:133], v[48:49], v[216:219]
v_mfma_f32_16x16x16_bf16 v[220:223], v[134:135], v[48:49], v[220:223]
v_and_b32 v50, v31, v8
v_and_b32 v51, v31, v9
s_waitcnt vmcnt(16)
s_nop 0
v_mfma_f32_16x16x16_bf16 v[208:211], v[136:137], v[50:51], v[208:211]
v_mfma_f32_16x16x16_bf16 v[212:215], v[138:139], v[50:51], v[212:215]
v_mfma_f32_16x16x16_bf16 v[216:219], v[140:141], v[50:51], v[216:219]
v_mfma_f32_16x16x16_bf16 v[220:223], v[142:143], v[50:51], v[220:223]
v_and_b32 v48, v32, v8
v_and_b32 v49, v32, v9
s_waitcnt vmcnt(14)
s_nop 0
v_mfma_f32_16x16x16_bf16 v[208:211], v[144:145], v[48:49], v[208:211]
v_mfma_f32_16x16x16_bf16 v[212:215], v[146:147], v[48:49], v[212:215]
v_mfma_f32_16x16x16_bf16 v[216:219], v[148:149], v[48:49], v[216:219]
v_mfma_f32_16x16x16_bf16 v[220:223], v[150:151], v[48:49], v[220:223]
v_and_b32 v50, v33, v8
v_and_b32 v51, v33, v9
s_waitcnt vmcnt(12)
s_nop 0
v_mfma_f32_16x16x16_bf16 v[208:211], v[152:153], v[50:51], v[208:211]
v_mfma_f32_16x16x16_bf16 v[212:215], v[154:155], v[50:51], v[212:215]
v_mfma_f32_16x16x16_bf16 v[216:219], v[156:157], v[50:51], v[216:219]
v_mfma_f32_16x16x16_bf16 v[220:223], v[158:159], v[50:51], v[220:223]
v_and_b32 v48, v34, v8
v_and_b32 v49, v34, v9
s_waitcnt vmcnt(10)
s_nop 0
v_mfma_f32_16x16x16_bf16 v[208:211], v[160:161], v[48:49], v[208:211]
v_mfma_f32_16x16x16_bf16 v[212:215], v[162:163], v[48:49], v[212:215]
v_mfma_f32_16x16x16_bf16 v[216:219], v[164:165], v[48:49], v[216:219]
v_mfma_f32_16x16x16_bf16 v[220:223], v[166:167], v[48:49], v[220:223]
v_and_b32 v50, v35, v8
v_and_b32 v51, v35, v9
s_waitcnt vmcnt(8)
s_nop 0
v_mfma_f32_16x16x16_bf16 v[208:211], v[168:169], v[50:51], v[208:211]
v_mfma_f32_16x16x16_bf16 v[212:215], v[170:171], v[50:51], v[212:215]
v_mfma_f32_16x16x16_bf16 v[216:219], v[172:173], v[50:51], v[216:219]
v_mfma_f32_16x16x16_bf16 v[220:223], v[174:175], v[50:51], v[220:223]
v_and_b32 v48, v36, v8
v_and_b32 v49, v36, v9
s_waitcnt vmcnt(6)
s_nop 0
v_mfma_f32_16x16x16_bf16 v[208:211], v[176:177], v[48:49], v[208:211]
v_mfma_f32_16x16x16_bf16 v[212:215], v[178:179], v[48:49], v[212:215]
v_mfma_f32_16x16x16_bf16 v[216:219], v[180:181], v[48:49], v[216:219]
v_mfma_f32_16x16x16_bf16 v[220:223], v[182:183], v[48:49], v[220:223]
v_and_b32 v50, v37, v8
v_and_b32 v51, v37, v9
s_waitcnt vmcnt(4)
s_nop 0
v_mfma_f32_16x16x16_bf16 v[208:211], v[184:185], v[50:51], v[208:211]
v_mfma_f32_16x16x16_bf16 v[212:215], v[186:187], v[50:51], v[212:215]
v_mfma_f32_16x16x16_bf16 v[216:219], v[188:189], v[50:51], v[216:219]
v_mfma_f32_16x16x16_bf16 v[220:223], v[190:191], v[50:51], v[220:223]
v_and_b32 v48, v38, v8
v_and_b32 v49, v38, v9
s_waitcnt vmcnt(2)
s_nop 0
v_mfma_f32_16x16x16_bf16 v[208:211], v[192:193], v[48:49], v[208:211]
v_mfma_f32_16x16x16_bf16 v[212:215], v[194:195], v[48:49], v[212:215]
v_mfma_f32_16x16x16_bf16 v[216:219], v[196:197], v[48:49], v[216:219]
v_mfma_f32_16x16x16_bf16 v[220:223], v[198:199], v[48:49], v[220:223]
v_and_b32 v50, v39, v8
v_and_b32 v51, v39, v9
s_waitcnt vmcnt(0)
s_nop 0
v_mfma_f32_16x16x16_bf16 v[208:211], v[200:201], v[50:51], v[208:211]
v_mfma_f32_16x16x16_bf16 v[212:215], v[202:203], v[50:51], v[212:215]
v_mfma_f32_16x16x16_bf16 v[216:219], v[204:205], v[50:51], v[216:219]
v_mfma_f32_16x16x16_bf16 v[220:223], v[206:207], v[50:51], v[220:223]
s_mov_b32 s78, s99
s_cmp_eq_u32 s61, 3
s_cselect_b32 s74, 1, 0
s_cmp_lt_u32 s99, 256
s_cselect_b32 s82, s74, 0
s_cmp_eq_u32 s82, 1
s_cbranch_scc0 L_nomore
s_add_u32 s99, s60, 256
s_lshr_b32 s74, s99, 2
s_lshl_b32 s74, s74, 7
s_and_b32 s75, s99, 3
s_mul_i32 s75, s75, 1327104
s_add_u32 s74, s74, s75
s_add_u32 s40, s16, s74
s_addc_u32 s41, s17, 0
s_mov_b32 s42, 1318016
s_mov_b32 s43, 0x20000
s_add_u32 s44, s18, s74
s_addc_u32 s45, s19, 0
s_mov_b32 s46, 1318016
s_mov_b32 s47, 0x20000
s_mov_b32 s80, 0
buffer_load_dwordx4 v[64:67], v5, s[40:43], s80 offen nt
buffer_load_dwordx4 v[68:71], v5, s[44:47], s80 offen nt
s_add_u32 s80, s80, 9216
buffer_load_dwordx4 v[72:75], v5, s[40:43], s80 offen nt
buffer_load_dwordx4 v[76:79], v5, s[44:47], s80 offen nt
s_add_u32 s80, s80, 9216
buffer_load_dwordx4 v[80:83], v5, s[40:43], s80 offen nt
buffer_load_dwordx4 v[84:87], v5, s[44:47], s80 offen nt
s_add_u32 s80, s80, 9216
buffer_load_dwordx4 v[88:91], v5, s[40:43], s80 offen nt
buffer_load_dwordx4 v[92:95], v5, s[44:47], s80 offen nt
s_add_u32 s80, s80, 9216
buffer_load_dwordx4 v[96:99], v5, s[40:43], s80 offen nt
buffer_load_dwordx4 v[100:103], v5, s[44:47], s80 offen nt
s_add_u32 s80, s80, 9216
buffer_load_dwordx4 v[104:107], v5, s[40:43], s80 offen nt
buffer_load_dwordx4 v[108:111], v5, s[44:47], s80 offen nt
s_add_u32 s80, s80, 9216
buffer_load_dwordx4 v[112:115], v5, s[40:43], s80 offen nt
buffer_load_dwordx4 v[116:119], v5, s[44:47], s80 offen nt
s_add_u32 s80, s80, 9216
buffer_load_dwordx4 v[120:123], v5, s[40:43], s80 offen nt
buffer_load_dwordx4 v[124:127], v5, s[44:47], s80 offen nt
s_add_u32 s80, s80, 9216
buffer_load_dwordx4 v[128:131], v5, s[40:43], s80 offen nt
buffer_load_dwordx4 v[132:135], v5, s[44:47], s80 offen nt
s_add_u32 s80, s80, 9216
buffer_load_dwordx4 v[136:139], v5, s[40:43], s80 offen nt
buffer_load_dwordx4 v[140:143], v5, s[44:47], s80 offen nt
s_add_u32 s80, s80, 9216
buffer_load_dwordx4 v[144:147], v5, s[40:43], s80 offen nt
buffer_load_dwordx4 v[148:151], v5, s[44:47], s80 offen nt
s_add_u32 s80, s80, 9216
buffer_load_dwordx4 v[152:155], v5, s[40:43], s80 offen nt
buffer_load_dwordx4 v[156:159], v5, s[44:47], s80 offen nt
s_add_u32 s80, s80, 9216
buffer_load_dwordx4 v[160:163], v5, s[40:43], s80 offen nt
buffer_load_dwordx4 v[164:167], v5, s[44:47], s80 offen nt
s_add_u32 s80, s80, 9216
buffer_load_dwordx4 v[168:171], v5, s[40:43], s80 offen nt
buffer_load_dwordx4 v[172:175], v5, s[44:47], s80 offen nt
s_add_u32 s80, s80, 9216
buffer_load_dwordx4 v[176:179], v5, s[40:43], s80 offen nt
buffer_load_dwordx4 v[180:183], v5, s[44:47], s80 offen nt
s_add_u32 s80, s80, 9216
buffer_load_dwordx4 v[184:187], v5, s[40:43], s80 offen nt
buffer_load_dwordx4 v[188:191], v5, s[44:47], s80 offen nt
s_add_u32 s80, s80, 9216
buffer_load_dwordx4 v[192:195], v5, s[40:43], s80 offen nt
buffer_load_dwordx4 v[196:199], v5, s[44:47], s80 offen nt
s_add_u32 s80, s80, 9216
buffer_load_dwordx4 v[200:203], v5, s[40:43], s80 offen nt
buffer_load_dwordx4 v[204:207], v5, s[44:47], s80 offen nt
L_nomore:
s_nop 3
s_mov_b32 exec_lo, 0x00ff00ff
s_mov_b32 exec_hi, 0xff00ff00
ds_write_b32 v11, v208 offset:5120
ds_write_b32 v11, v209 offset:5152
ds_write_b32 v11, v210 offset:5184
ds_write_b32 v11, v211 offset:5216
ds_write_b32 v11, v212 offset:5136
ds_write_b32 v11, v213 offset:5168
ds_write_b32 v11, v214 offset:5200
ds_write_b32 v11, v215 offset:5232
ds_write_b32 v11, v216 offset:6144
ds_write_b32 v11, v217 offset:6176
ds_write_b32 v11, v218 offset:6208
ds_write_b32 v11, v219 offset:6240
ds_write_b32 v11, v220 offset:6160
ds_write_b32 v11, v221 offset:6192
ds_write_b32 v11, v222 offset:6224
ds_write_b32 v11, v223 offset:6256
s_mov_b64 exec, -1
s_waitcnt lgkmcnt(0)
ds_read_b64 v[44:45], v12 offset:5120
ds_read_b64 v[46:47], v12 offset:5632
ds_read_b64 v[48:49], v12 offset:6144
ds_read_b64 v[50:51], v12 offset:6656
s_lshl_b32 s77, s78, 10
s_add_u32 s77, s77, 917504
s_waitcnt lgkmcnt(0)
v_add_f32 v44, v44, v46
v_add_f32 v45, v45, v47
v_add_f32 v46, v48, v50
v_add_f32 v47, v49, v51
s_mov_b32 s69, 320000
L_fq:
ds_read_b32 v40, v18 offset:4
s_waitcnt lgkmcnt(0)
v_readfirstlane_b32 s74, v40
s_sub_u32 s69, s69, 1
s_cmp_eq_u32 s69, 0
s_cbranch_scc1 L_fqd
s_cmp_ge_u32 s74, 1
s_cbranch_scc1 L_fqd
s_sleep 2
s_branch L_fq
L_fqd:
ds_read_b32 v19, v18 offset:8
ds_read_b32 v40, v18 offset:12
s_waitcnt lgkmcnt(0)
v_readfirstlane_b32 s66, v19
v_readfirstlane_b32 s67, v40
v_lshrrev_b32 v14, 8, v19
v_lshrrev_b32 v15, 16, v19
v_lshrrev_b32 v16, 24, v19
v_add_u32 v44, 0x80, v44
v_bfi_b32 v44, v3, v19, v44
v_add_u32 v45, 0x80, v45
v_bfi_b32 v45, v3, v14, v45
v_add_u32 v46, 0x80, v46
v_bfi_b32 v46, v3, v15, v46
v_add_u32 v47, 0x80, v47
v_bfi_b32 v47, v3, v16, v47
s_cmp_lt_u32 s78, 256
s_cselect_b32 s80, s67, 0
s_cmp_eq_u32 s80, 1
s_cbranch_scc1 L_fpf
buffer_store_dwordx4 v[44:47], v13, s[36:39], s77 offen sc1 nt
s_branch L_fpe
L_fpf:
buffer_store_dwordx4 v[44:47], v13, s[36:39], s77 offen
L_fpe:
s_cmp_eq_u32 s82, 1
s_cbranch_scc1 L_piece
s_setprio 1
s_and_b32 s74, s78, 3
s_cmp_eq_u32 s74, 0
s_cbranch_scc0 L_idle2
s_mov_b32 s69, 320000
L_gwait:
ds_read_b32 v40, v18 offset:0
s_waitcnt lgkmcnt(0)
v_readfirstlane_b32 s74, v40
s_sub_u32 s69, s69, 1
s_cmp_eq_u32 s69, 0
s_cbranch_scc1 L_gwaitd
s_cmp_ge_u32 s74, 72
s_cbranch_scc1 L_gwaitd
s_sleep 16
s_branch L_gwait
L_gwaitd:
s_lshl_b32 s74, s78, 10
s_add_u32 s74, s74, 917504
s_mov_b32 s69, 40000
L_fpoll:
s_cmp_lt_u32 s78, 256
s_cselect_b32 s80, s67, 0
s_cmp_eq_u32 s80, 1
s_cbranch_scc1 L_lp1037f
buffer_load_dwordx4 v[64:67], v13, s[36:39], s74 offen offset:0 sc1
buffer_load_dwordx4 v[68:71], v13, s[36:39], s74 offen offset:1024 sc1
buffer_load_dwordx4 v[72:75], v13, s[36:39], s74 offen offset:2048 sc1
buffer_load_dwordx4 v[76:79], v13, s[36:39], s74 offen offset:3072 sc1
s_branch L_lp1037e
L_lp1037f:
buffer_load_dwordx4 v[64:67], v13, s[36:39], s74 offen offset:0 nt
buffer_load_dwordx4 v[68:71], v13, s[36:39], s74 offen offset:1024 nt
buffer_load_dwordx4 v[72:75], v13, s[36:39], s74 offen offset:2048 nt
buffer_load_dwordx4 v[76:79], v13, s[36:39], s74 offen offset:3072 nt
L_lp1037e:
s_waitcnt vmcnt(0)
v_xor_b32 v7, v19, v64
v_xor_b32 v46, v14, v65
v_or_b32 v7, v7, v46
v_xor_b32 v46, v15, v66
v_or_b32 v7, v7, v46
v_xor_b32 v46, v16, v67
v_or_b32 v7, v7, v46
v_xor_b32 v46, v19, v68
v_or_b32 v7, v7, v46
v_xor_b32 v46, v14, v69
v_or_b32 v7, v7, v46
v_xor_b32 v46, v15, v70
v_or_b32 v7, v7, v46
v_xor_b32 v46, v16, v71
v_or_b32 v7, v7, v46
v_xor_b32 v46, v19, v72
v_or_b32 v7, v7, v46
v_xor_b32 v46, v14, v73
v_or_b32 v7, v7, v46
v_xor_b32 v46, v15, v74
v_or_b32 v7, v7, v46
v_xor_b32 v46, v16, v75
v_or_b32 v7, v7, v46
v_xor_b32 v46, v19, v76
v_or_b32 v7, v7, v46
v_xor_b32 v46, v14, v77
v_or_b32 v7, v7, v46
v_xor_b32 v46, v15, v78
v_or_b32 v7, v7, v46
v_xor_b32 v46, v16, v79
v_or_b32 v7, v7, v46
v_and_b32 v7, 0xff, v7
v_cmp_ne_u32 vcc, 0, v7
s_cbranch_vccz L_fpolld
s_sub_u32 s69, s69, 1
s_cmp_eq_u32 s69, 0
s_cbranch_scc1 L_fpolld
s_sleep 48
s_branch L_fpoll
L_fpolld:
v_mov_b32 v6, 0xffffff00
v_and_b32 v64, v6, v64
v_and_b32 v65, v6, v65
v_and_b32 v66, v6, v66
v_and_b32 v67, v6, v67
v_and_b32 v68, v6, v68
v_and_b32 v69, v6, v69
v_and_b32 v70, v6, v70
v_and_b32 v71, v6, v71
v_and_b32 v72, v6, v72
v_and_b32 v73, v6, v73
v_and_b32 v74, v6, v74
v_and_b32 v75, v6, v75
v_and_b32 v76, v6, v76
v_and_b32 v77, v6, v77
v_and_b32 v78, v6, v78
v_and_b32 v79, v6, v79
v_add_f32 v44, v64, v68
v_add_f32 v46, v72, v76
v_add_f32 v44, v44, v46
v_add_f32 v45, v65, v69
v_add_f32 v46, v73, v77
v_add_f32 v45, v45, v46
v_add_f32 v48, v66, v70
v_add_f32 v46, v74, v78
v_add_f32 v48, v48, v46
v_add_f32 v49, v67, v71
v_add_f32 v46, v75, v79
v_add_f32 v49, v49, v46
v_cvt_pk_bf16_f32 v46, v44, v45
v_cvt_pk_bf16_f32 v50, v48, v49
v_lshlrev_b32 v44, 16, v46
v_and_b32 v45, 0xffff0000, v46
v_lshlrev_b32 v48, 16, v50
v_and_b32 v49, 0xffff0000, v50
s_mov_b32 s74, 0x3d372713
v_mul_f32 v46, v44, v44
v_fma_f32 v46, v46, s74, 1.0
v_mul_f32 v46, v46, v44
v_mul_f32 v46, 0xc0135761, v46
v_exp_f32 v46, v46
s_nop 0
v_add_f32 v46, 1.0, v46
v_rcp_f32 v46, v46
s_nop 0
v_mul_f32 v46, v46, v44
v_mul_f32 v47, v45, v45
v_fma_f32 v47, v47, s74, 1.0
v_mul_f32 v47, v47, v45
v_mul_f32 v47, 0xc0135761, v47
v_exp_f32 v47, v47
s_nop 0
v_add_f32 v47, 1.0, v47
v_rcp_f32 v47, v47
s_nop 0
v_mul_f32 v47, v47, v45
v_cvt_pk_bf16_f32 v46, v46, v47
v_lshlrev_b32 v44, 16, v46
v_and_b32 v45, 0xffff0000, v46
v_mul_f32 v44, v44, v48
v_mul_f32 v45, v45, v49
v_cvt_pk_bf16_f32 v16, v44, v45
v_mov_b32 v17, v19
v_lshrrev_b32 v6, 5, v0
v_mul_u32_u24 v6, 18432, v6
v_and_b32 v7, 31, v0
v_lshl_add_u32 v14, v7, 3, v6
s_lshl_b32 s74, s78, 6
s_add_u32 s74, s74, 524288
buffer_store_dwordx2 v[16:17], v14, s[36:39], s74 offen sc1
s_branch L_idle2
L_idle:
s_barrier
s_mov_b32 s69, 320000
L_iq:
ds_read_b32 v40, v18 offset:4
s_waitcnt lgkmcnt(0)
v_readfirstlane_b32 s74, v40
s_sub_u32 s69, s69, 1
s_cmp_eq_u32 s69, 0
s_cbranch_scc1 L_iqd
s_cmp_ge_u32 s74, 1
s_cbranch_scc1 L_iqd
s_sleep 4
s_branch L_iq
L_iqd:
ds_read_b32 v19, v18 offset:8
ds_read_b32 v40, v18 offset:12
s_waitcnt lgkmcnt(0)
v_readfirstlane_b32 s66, v19
v_readfirstlane_b32 s67, v40
L_idle2:
s_setprio 1
s_lshl_b32 s74, s60, 7
s_lshl_b32 s75, s64, 4
s_add_u32 s74, s74, s75
s_mul_i32 s74, s74, 1152
s_lshl_b32 s76, s61, 7
s_add_u32 s74, s74, s76
s_sub_u32 s77, 18432, s76
s_add_u32 s56, s12, s74
s_addc_u32 s57, s13, 0
s_mov_b32 s58, s77
s_mov_b32 s59, 0x20000
s_mul_i32 s74, s60, 144
s_mul_i32 s75, s64, 18
s_add_u32 s74, s74, s75
s_mul_i32 s74, s74, 1152
s_add_u32 s74, s74, s76
s_sub_u32 s77, 20736, s76
s_add_u32 s84, s20, s74
s_addc_u32 s85, s21, 0
s_mov_b32 s86, s77
s_mov_b32 s87, 0x20000
s_cmp_eq_u32 s61, 7
s_cselect_b32 s82, 1, 0
v_lshrrev_b32 v54, 3, v2
v_lshl_add_u32 v54, v1, 1, v54
v_mul_u32_u24 v54, 1152, v54
v_and_b32 v53, 7, v0
v_lshl_add_u32 v54, v53, 4, v54
s_waitcnt vmcnt(0)
s_cmp_eq_u32 s82, 1
s_cselect_b32 s78, 64, 0x20000000
s_lshl_b32 s78, s78, 1
s_add_u32 s74, s78, 0
buffer_load_dwordx4 v[212:215], v54, s[56:59], s74 offen nt
s_add_u32 s74, s78, 9216
buffer_load_dwordx4 v[216:219], v54, s[56:59], s74 offen nt
s_add_u32 s74, s78, 0
buffer_load_dwordx4 v[220:223], v54, s[84:87], s74 offen nt
s_add_u32 s74, s78, 9216
buffer_load_dwordx4 v[224:227], v54, s[84:87], s74 offen nt
s_add_u32 s74, s78, 18432
buffer_load_dwordx4 v[228:231], v54, s[84:87], s74 offen nt
s_add_u32 s75, s3, 4
s_mov_b32 s69, 320000
L_iwait:
ds_read_b32 v40, v18 offset:0
s_waitcnt lgkmcnt(0)
v_readfirstlane_b32 s74, v40
s_sub_u32 s69, s69, 1
s_cmp_eq_u32 s69, 0
s_cbranch_scc1 L_iwaitd
s_cmp_ge_u32 s74, s75
s_cbranch_scc1 L_iwaitd
s_sleep 8
s_branch L_iwait
L_iwaitd:
s_mov_b32 s74, 0
buffer_load_dwordx4 v[192:195], v54, s[56:59], s74 offen nt
s_mov_b32 s74, 9216
buffer_load_dwordx4 v[196:199], v54, s[56:59], s74 offen nt
s_mov_b32 s74, 0
buffer_load_dwordx4 v[200:203], v54, s[84:87], s74 offen nt
s_mov_b32 s74, 9216
buffer_load_dwordx4 v[204:207], v54, s[84:87], s74 offen nt
s_mov_b32 s74, 18432
buffer_load_dwordx4 v[208:211], v54, s[84:87], s74 offen nt
s_branch L_bar2
L_attn:
s_mov_b32 s65, s64
s_lshl_b32 s101, s64, 8
s_lshl_b32 s74, s62, 5
s_add_u32 s74, s74, s60
s_lshl_b32 s74, s74, 21
s_add_u32 s28, s6, s74
s_addc_u32 s29, s7, 0
s_mov_b32 s30, 2097152
s_mov_b32 s31, 0x20000
s_add_u32 s32, s8, s74
s_addc_u32 s33, s9, 0
s_mov_b32 s34, 2097152
s_mov_b32 s35, 0x20000
s_lshl_b32 s14, s63, 7
s_add_u32 s15, s63, 509
v_and_b32 v3, 3, v0
v_lshlrev_b32 v3, 2, v3
v_bfe_u32 v5, v0, 2, 2
v_add_u32 v3, v3, v5
v_lshlrev_b32 v3, 8, v3
v_lshl_add_u32 v3, v1, 4, v3
v_lshlrev_b32 v4, 4, v0
s_add_u32 s70, s65, 0
s_add_u32 s80, s70, s14
s_lshl_b32 s80, s80, 12
buffer_load_dwordx4 v[64:67], v3, s[28:31], s80 offen offset:0 nt
buffer_load_dwordx4 v[68:71], v3, s[28:31], s80 offen offset:64 nt
buffer_load_dwordx4 v[72:75], v3, s[28:31], s80 offen offset:128 nt
buffer_load_dwordx4 v[76:79], v3, s[28:31], s80 offen offset:192 nt
buffer_load_dwordx4 v[80:83], v4, s[32:35], s80 offen offset:0 nt
buffer_load_dwordx4 v[84:87], v4, s[32:35], s80 offen offset:1024 nt
buffer_load_dwordx4 v[88:91], v4, s[32:35], s80 offen offset:2048 nt
buffer_load_dwordx4 v[92:95], v4, s[32:35], s80 offen offset:3072 nt
v_and_b32 v5, 1, v0
v_lshlrev_b32 v5, 4, v5
v_mov_b32 v40, 0xffff
v_lshlrev_b32 v40, v5, v40
v_lshrrev_b32 v5, 1, v2
v_cmp_eq_u32 vcc, 0, v5
s_nop 1
v_cndmask_b32 v6, 0, v40, vcc
v_cmp_eq_u32 vcc, 1, v5
s_nop 1
v_cndmask_b32 v7, 0, v40, vcc
v_cmp_eq_u32 vcc, 2, v5
s_nop 1
v_cndmask_b32 v8, 0, v40, vcc
v_cmp_eq_u32 vcc, 3, v5
s_nop 1
v_cndmask_b32 v9, 0, v40, vcc
v_mov_b32 v12, 0
v_mov_b32 v13, 0
v_mov_b32 v14, 0
v_mov_b32 v15, 0
v_mov_b32 v10, 0xff800000
v_mov_b32 v11, 0xff800000
v_mov_b32 v16, 0
v_mov_b32 v19, 1
v_lshlrev_b32 v5, 4, v1
s_lshl_b32 s74, s60, 7
s_lshl_b32 s75, s64, 4
s_add_u32 s74, s74, s75
s_mul_i32 s74, s74, 1152
s_lshl_b32 s76, s61, 7
s_add_u32 s74, s74, s76
s_sub_u32 s77, 18432, s76
s_add_u32 s56, s12, s74
s_addc_u32 s57, s13, 0
s_mov_b32 s58, s77
s_mov_b32 s59, 0x20000
s_mul_i32 s74, s60, 144
s_mul_i32 s75, s64, 18
s_add_u32 s74, s74, s75
s_mul_i32 s74, s74, 1152
s_add_u32 s74, s74, s76
s_sub_u32 s77, 20736, s76
s_add_u32 s84, s20, s74
s_addc_u32 s85, s21, 0
s_mov_b32 s86, s77
s_mov_b32 s87, 0x20000
s_cmp_eq_u32 s61, 7
s_cselect_b32 s82, 1, 0
v_lshrrev_b32 v54, 3, v2
v_lshl_add_u32 v54, v1, 1, v54
v_mul_u32_u24 v54, 1152, v54
v_and_b32 v53, 7, v0
v_lshl_add_u32 v54, v53, 4, v54
s_barrier
s_add_u32 s71, s65, 4
s_add_u32 s80, s71, s14
s_lshl_b32 s80, s80, 12
buffer_load_dwordx4 v[96:99], v3, s[28:31], s80 offen offset:0 nt
buffer_load_dwordx4 v[100:103], v3, s[28:31], s80 offen offset:64 nt
buffer_load_dwordx4 v[104:107], v3, s[28:31], s80 offen offset:128 nt
buffer_load_dwordx4 v[108:111], v3, s[28:31], s80 offen offset:192 nt
s_waitcnt vmcnt(8)
buffer_load_dwordx4 v[112:115], v4, s[32:35], s80 offen offset:0 nt
buffer_load_dwordx4 v[116:119], v4, s[32:35], s80 offen offset:1024 nt
buffer_load_dwordx4 v[120:123], v4, s[32:35], s80 offen offset:2048 nt
buffer_load_dwordx4 v[124:127], v4, s[32:35], s80 offen offset:3072 nt
s_add_u32 s72, s65, 8
s_add_u32 s80, s72, s14
s_lshl_b32 s80, s80, 12
s_waitcnt vmcnt(8)
buffer_load_dwordx4 v[128:131], v3, s[28:31], s80 offen offset:0 nt
buffer_load_dwordx4 v[132:135], v3, s[28:31], s80 offen offset:64 nt
buffer_load_dwordx4 v[136:139], v3, s[28:31], s80 offen offset:128 nt
buffer_load_dwordx4 v[140:143], v3, s[28:31], s80 offen offset:192 nt
s_waitcnt vmcnt(8)
buffer_load_dwordx4 v[144:147], v4, s[32:35], s80 offen offset:0 nt
buffer_load_dwordx4 v[148:151], v4, s[32:35], s80 offen offset:1024 nt
buffer_load_dwordx4 v[152:155], v4, s[32:35], s80 offen offset:2048 nt
buffer_load_dwordx4 v[156:159], v4, s[32:35], s80 offen offset:3072 nt
s_add_u32 s73, s65, 12
s_add_u32 s80, s73, s14
s_lshl_b32 s80, s80, 12
s_waitcnt vmcnt(8)
buffer_load_dwordx4 v[160:163], v3, s[28:31], s80 offen offset:0 nt
buffer_load_dwordx4 v[164:167], v3, s[28:31], s80 offen offset:64 nt
buffer_load_dwordx4 v[168:171], v3, s[28:31], s80 offen offset:128 nt
buffer_load_dwordx4 v[172:175], v3, s[28:31], s80 offen offset:192 nt
s_waitcnt vmcnt(8)
buffer_load_dwordx4 v[176:179], v4, s[32:35], s80 offen offset:0 nt
buffer_load_dwordx4 v[180:183], v4, s[32:35], s80 offen offset:1024 nt
buffer_load_dwordx4 v[184:187], v4, s[32:35], s80 offen offset:2048 nt
buffer_load_dwordx4 v[188:191], v4, s[32:35], s80 offen offset:3072 nt
s_add_u32 s83, s65, 16
s_add_u32 s80, s83, s14
s_lshl_b32 s80, s80, 12
s_waitcnt vmcnt(8)
buffer_load_dwordx4 v[192:195], v3, s[28:31], s80 offen offset:0 nt
buffer_load_dwordx4 v[196:199], v3, s[28:31], s80 offen offset:64 nt
buffer_load_dwordx4 v[200:203], v3, s[28:31], s80 offen offset:128 nt
buffer_load_dwordx4 v[204:207], v3, s[28:31], s80 offen offset:192 nt
s_waitcnt vmcnt(8)
buffer_load_dwordx4 v[208:211], v4, s[32:35], s80 offen offset:0 nt
buffer_load_dwordx4 v[212:215], v4, s[32:35], s80 offen offset:1024 nt
buffer_load_dwordx4 v[216:219], v4, s[32:35], s80 offen offset:2048 nt
buffer_load_dwordx4 v[220:223], v4, s[32:35], s80 offen offset:3072 nt
s_add_u32 s100, s65, 20
s_add_u32 s80, s100, s14
s_lshl_b32 s80, s80, 12
s_waitcnt vmcnt(8)
buffer_load_dwordx4 v[224:227], v3, s[28:31], s80 offen offset:0 nt
buffer_load_dwordx4 v[228:231], v3, s[28:31], s80 offen offset:64 nt
buffer_load_dwordx4 v[232:235], v3, s[28:31], s80 offen offset:128 nt
buffer_load_dwordx4 v[236:239], v3, s[28:31], s80 offen offset:192 nt
s_waitcnt vmcnt(8)
buffer_load_dwordx4 v[240:243], v4, s[32:35], s80 offen offset:0 nt
buffer_load_dwordx4 v[244:247], v4, s[32:35], s80 offen offset:1024 nt
buffer_load_dwordx4 v[248:251], v4, s[32:35], s80 offen offset:2048 nt
buffer_load_dwordx4 v[252:255], v4, s[32:35], s80 offen offset:3072 nt
s_mov_b32 s69, 320000
L_aq:
ds_read_b32 v40, v18 offset:4
s_waitcnt lgkmcnt(0)
v_readfirstlane_b32 s74, v40
s_sub_u32 s69, s69, 1
s_cmp_eq_u32 s69, 0
s_cbranch_scc1 L_aqd
s_cmp_ge_u32 s74, 1
s_cbranch_scc1 L_aqd
s_sleep 1
s_branch L_aq
L_aqd:
ds_read_b128 v[20:23], v5 offset:64
ds_read_b128 v[24:27], v5 offset:128
ds_read_b128 v[28:31], v5 offset:192
ds_read_b128 v[32:35], v5 offset:256
ds_read_b64 v[40:41], v18 offset:8
s_mov_b64 exec, 1
ds_add_rtn_u32 v17, v18, v19 offset:0
s_mov_b64 exec, -1
s_waitcnt lgkmcnt(0)
v_readfirstlane_b32 s66, v40
v_readfirstlane_b32 s67, v41
s_mov_b32 s81, 0
s_waitcnt vmcnt(44)
v_mfma_f32_16x16x32_bf16 v[36:39], v[64:67], v[20:23], 0
v_mfma_f32_16x16x32_bf16 v[36:39], v[68:71], v[24:27], v[36:39]
v_mfma_f32_16x16x32_bf16 v[36:39], v[72:75], v[28:31], v[36:39]
v_mfma_f32_16x16x32_bf16 v[36:39], v[76:79], v[32:35], v[36:39]
s_waitcnt lgkmcnt(0)
v_readfirstlane_b32 s70, v17
s_mov_b64 exec, 1
ds_add_rtn_u32 v17, v18, v19 offset:0
s_mov_b64 exec, -1
s_add_u32 s74, s70, s14
s_cmp_lt_u32 s70, 128
s_cselect_b32 s74, s74, s15
s_cmp_lt_u32 s70, s3
s_cselect_b32 s74, s74, 0x200
s_lshl_b32 s80, s74, 12
buffer_load_dwordx4 v[64:67], v3, s[28:31], s80 offen offset:0 nt
buffer_load_dwordx4 v[68:71], v3, s[28:31], s80 offen offset:64 nt
buffer_load_dwordx4 v[72:75], v3, s[28:31], s80 offen offset:128 nt
buffer_load_dwordx4 v[76:79], v3, s[28:31], s80 offen offset:192 nt
v_cvt_pk_bf16_f32 v40, v36, v37
v_cvt_pk_bf16_f32 v41, v38, v39
v_lshlrev_b32 v42, 16, v40
v_and_b32 v43, 0xffff0000, v40
v_lshlrev_b32 v44, 16, v41
v_and_b32 v45, 0xffff0000, v41
v_mul_f32 v42, 0x3db504f3, v42
v_mul_f32 v43, 0x3db504f3, v43
v_mul_f32 v44, 0x3db504f3, v44
v_mul_f32 v45, 0x3db504f3, v45
v_cvt_pk_bf16_f32 v40, v42, v43
v_cvt_pk_bf16_f32 v41, v44, v45
v_lshlrev_b32 v42, 16, v40
v_and_b32 v43, 0xffff0000, v40
v_lshlrev_b32 v44, 16, v41
v_and_b32 v45, 0xffff0000, v41
v_max3_f32 v46, v42, v43, v44
v_max3_f32 v46, v46, v45, v10
v_mov_b32 v47, v46
s_nop 1
v_permlane32_swap_b32 v46, v47
v_max_f32 v46, v46, v47
v_mov_b32 v47, v46
s_nop 1
v_permlane16_swap_b32 v46, v47
v_max_f32 v46, v46, v47
v_mov_b32 v10, v46
v_mul_f32 v47, s79, v46
v_sub_f32 v48, v11, v47
v_exp_f32 v48, v48
v_fma_f32 v42, v42, s79, -v47
v_fma_f32 v43, v43, s79, -v47
v_fma_f32 v44, v44, s79, -v47
v_fma_f32 v45, v45, s79, -v47
v_exp_f32 v42, v42
v_exp_f32 v43, v43
v_exp_f32 v44, v44
v_exp_f32 v45, v45
v_mov_b32 v11, v47
v_mul_f32 v12, v12, v48
v_mul_f32 v13, v13, v48
v_mul_f32 v14, v14, v48
v_mul_f32 v15, v15, v48
v_add_f32 v49, v42, v43
v_add_f32 v50, v44, v45
v_add_f32 v49, v49, v50
v_fma_f32 v16, v16, v48, v49
v_cvt_pk_bf16_f32 v42, v42, v42
v_cvt_pk_bf16_f32 v43, v43, v43
v_cvt_pk_bf16_f32 v44, v44, v44
v_cvt_pk_bf16_f32 v45, v45, v45
v_and_b32 v56, v42, v6
v_and_b32 v57, v42, v7
v_and_b32 v58, v42, v8
v_and_b32 v59, v42, v9
s_waitcnt vmcnt(44)
s_nop 0
v_mfma_f32_16x16x32_bf16 v[12:15], v[80:83], v[56:59], v[12:15]
v_and_b32 v60, v43, v6
v_and_b32 v61, v43, v7
v_and_b32 v62, v43, v8
v_and_b32 v63, v43, v9
s_nop 1
v_mfma_f32_16x16x32_bf16 v[12:15], v[84:87], v[60:63], v[12:15]
v_and_b32 v56, v44, v6
v_and_b32 v57, v44, v7
v_and_b32 v58, v44, v8
v_and_b32 v59, v44, v9
s_nop 1
v_mfma_f32_16x16x32_bf16 v[12:15], v[88:91], v[56:59], v[12:15]
v_and_b32 v60, v45, v6
v_and_b32 v61, v45, v7
v_and_b32 v62, v45, v8
v_and_b32 v63, v45, v9
s_nop 1
v_mfma_f32_16x16x32_bf16 v[12:15], v[92:95], v[60:63], v[12:15]
buffer_load_dwordx4 v[80:83], v4, s[32:35], s80 offen offset:0 nt
buffer_load_dwordx4 v[84:87], v4, s[32:35], s80 offen offset:1024 nt
buffer_load_dwordx4 v[88:91], v4, s[32:35], s80 offen offset:2048 nt
buffer_load_dwordx4 v[92:95], v4, s[32:35], s80 offen offset:3072 nt
s_waitcnt vmcnt(44)
v_mfma_f32_16x16x32_bf16 v[36:39], v[96:99], v[20:23], 0
v_mfma_f32_16x16x32_bf16 v[36:39], v[100:103], v[24:27], v[36:39]
v_mfma_f32_16x16x32_bf16 v[36:39], v[104:107], v[28:31], v[36:39]
v_mfma_f32_16x16x32_bf16 v[36:39], v[108:111], v[32:35], v[36:39]
s_waitcnt lgkmcnt(0)
v_readfirstlane_b32 s71, v17
s_mov_b64 exec, 1
ds_add_rtn_u32 v17, v18, v19 offset:0
s_mov_b64 exec, -1
s_add_u32 s74, s71, s14
s_cmp_lt_u32 s71, 128
s_cselect_b32 s74, s74, s15
s_cmp_lt_u32 s71, s3
s_cselect_b32 s74, s74, 0x200
s_lshl_b32 s80, s74, 12
buffer_load_dwordx4 v[96:99], v3, s[28:31], s80 offen offset:0 nt
buffer_load_dwordx4 v[100:103], v3, s[28:31], s80 offen offset:64 nt
buffer_load_dwordx4 v[104:107], v3, s[28:31], s80 offen offset:128 nt
buffer_load_dwordx4 v[108:111], v3, s[28:31], s80 offen offset:192 nt
v_cvt_pk_bf16_f32 v40, v36, v37
v_cvt_pk_bf16_f32 v41, v38, v39
v_lshlrev_b32 v42, 16, v40
v_and_b32 v43, 0xffff0000, v40
v_lshlrev_b32 v44, 16, v41
v_and_b32 v45, 0xffff0000, v41
v_mul_f32 v42, 0x3db504f3, v42
v_mul_f32 v43, 0x3db504f3, v43
v_mul_f32 v44, 0x3db504f3, v44
v_mul_f32 v45, 0x3db504f3, v45
v_cvt_pk_bf16_f32 v40, v42, v43
v_cvt_pk_bf16_f32 v41, v44, v45
v_lshlrev_b32 v42, 16, v40
v_and_b32 v43, 0xffff0000, v40
v_lshlrev_b32 v44, 16, v41
v_and_b32 v45, 0xffff0000, v41
v_max3_f32 v46, v42, v43, v44
v_max3_f32 v46, v46, v45, v10
v_mov_b32 v47, v46
s_nop 1
v_permlane32_swap_b32 v46, v47
v_max_f32 v46, v46, v47
v_mov_b32 v47, v46
s_nop 1
v_permlane16_swap_b32 v46, v47
v_max_f32 v46, v46, v47
v_mov_b32 v10, v46
v_mul_f32 v47, s79, v46
v_sub_f32 v48, v11, v47
v_exp_f32 v48, v48
v_fma_f32 v42, v42, s79, -v47
v_fma_f32 v43, v43, s79, -v47
v_fma_f32 v44, v44, s79, -v47
v_fma_f32 v45, v45, s79, -v47
v_exp_f32 v42, v42
v_exp_f32 v43, v43
v_exp_f32 v44, v44
v_exp_f32 v45, v45
v_mov_b32 v11, v47
v_mul_f32 v12, v12, v48
v_mul_f32 v13, v13, v48
v_mul_f32 v14, v14, v48
v_mul_f32 v15, v15, v48
v_add_f32 v49, v42, v43
v_add_f32 v50, v44, v45
v_add_f32 v49, v49, v50
v_fma_f32 v16, v16, v48, v49
v_cvt_pk_bf16_f32 v42, v42, v42
v_cvt_pk_bf16_f32 v43, v43, v43
v_cvt_pk_bf16_f32 v44, v44, v44
v_cvt_pk_bf16_f32 v45, v45, v45
v_and_b32 v56, v42, v6
v_and_b32 v57, v42, v7
v_and_b32 v58, v42, v8
v_and_b32 v59, v42, v9
s_waitcnt vmcnt(44)
s_nop 0
v_mfma_f32_16x16x32_bf16 v[12:15], v[112:115], v[56:59], v[12:15]
v_and_b32 v60, v43, v6
v_and_b32 v61, v43, v7
v_and_b32 v62, v43, v8
v_and_b32 v63, v43, v9
s_nop 1
v_mfma_f32_16x16x32_bf16 v[12:15], v[116:119], v[60:63], v[12:15]
v_and_b32 v56, v44, v6
v_and_b32 v57, v44, v7
v_and_b32 v58, v44, v8
v_and_b32 v59, v44, v9
s_nop 1
v_mfma_f32_16x16x32_bf16 v[12:15], v[120:123], v[56:59], v[12:15]
v_and_b32 v60, v45, v6
v_and_b32 v61, v45, v7
v_and_b32 v62, v45, v8
v_and_b32 v63, v45, v9
s_nop 1
v_mfma_f32_16x16x32_bf16 v[12:15], v[124:127], v[60:63], v[12:15]
buffer_load_dwordx4 v[112:115], v4, s[32:35], s80 offen offset:0 nt
buffer_load_dwordx4 v[116:119], v4, s[32:35], s80 offen offset:1024 nt
buffer_load_dwordx4 v[120:123], v4, s[32:35], s80 offen offset:2048 nt
buffer_load_dwordx4 v[124:127], v4, s[32:35], s80 offen offset:3072 nt
s_waitcnt vmcnt(44)
v_mfma_f32_16x16x32_bf16 v[36:39], v[128:131], v[20:23], 0
v_mfma_f32_16x16x32_bf16 v[36:39], v[132:135], v[24:27], v[36:39]
v_mfma_f32_16x16x32_bf16 v[36:39], v[136:139], v[28:31], v[36:39]
v_mfma_f32_16x16x32_bf16 v[36:39], v[140:143], v[32:35], v[36:39]
s_nop 7
v_cvt_pk_bf16_f32 v40, v36, v37
v_cvt_pk_bf16_f32 v41, v38, v39
v_lshlrev_b32 v42, 16, v40
v_and_b32 v43, 0xffff0000, v40
v_lshlrev_b32 v44, 16, v41
v_and_b32 v45, 0xffff0000, v41
v_mul_f32 v42, 0x3db504f3, v42
v_mul_f32 v43, 0x3db504f3, v43
v_mul_f32 v44, 0x3db504f3, v44
v_mul_f32 v45, 0x3db504f3, v45
v_cvt_pk_bf16_f32 v40, v42, v43
v_cvt_pk_bf16_f32 v41, v44, v45
v_lshlrev_b32 v42, 16, v40
v_and_b32 v43, 0xffff0000, v40
v_lshlrev_b32 v44, 16, v41
v_and_b32 v45, 0xffff0000, v41
v_max3_f32 v46, v42, v43, v44
v_max3_f32 v46, v46, v45, v10
v_mov_b32 v47, v46
s_nop 1
v_permlane32_swap_b32 v46, v47
v_max_f32 v46, v46, v47
v_mov_b32 v47, v46
s_nop 1
v_permlane16_swap_b32 v46, v47
v_max_f32 v46, v46, v47
v_mov_b32 v10, v46
v_mul_f32 v47, s79, v46
v_sub_f32 v48, v11, v47
v_exp_f32 v48, v48
v_fma_f32 v42, v42, s79, -v47
v_fma_f32 v43, v43, s79, -v47
v_fma_f32 v44, v44, s79, -v47
v_fma_f32 v45, v45, s79, -v47
v_exp_f32 v42, v42
v_exp_f32 v43, v43
v_exp_f32 v44, v44
v_exp_f32 v45, v45
v_mov_b32 v11, v47
v_mul_f32 v12, v12, v48
v_mul_f32 v13, v13, v48
v_mul_f32 v14, v14, v48
v_mul_f32 v15, v15, v48
v_add_f32 v49, v42, v43
v_add_f32 v50, v44, v45
v_add_f32 v49, v49, v50
v_fma_f32 v16, v16, v48, v49
v_cvt_pk_bf16_f32 v42, v42, v42
v_cvt_pk_bf16_f32 v43, v43, v43
v_cvt_pk_bf16_f32 v44, v44, v44
v_cvt_pk_bf16_f32 v45, v45, v45
v_and_b32 v56, v42, v6
v_and_b32 v57, v42, v7
v_and_b32 v58, v42, v8
v_and_b32 v59, v42, v9
s_waitcnt vmcnt(40)
s_nop 0
v_mfma_f32_16x16x32_bf16 v[12:15], v[144:147], v[56:59], v[12:15]
v_and_b32 v60, v43, v6
v_and_b32 v61, v43, v7
v_and_b32 v62, v43, v8
v_and_b32 v63, v43, v9
s_nop 1
v_mfma_f32_16x16x32_bf16 v[12:15], v[148:151], v[60:63], v[12:15]
v_and_b32 v56, v44, v6
v_and_b32 v57, v44, v7
v_and_b32 v58, v44, v8
v_and_b32 v59, v44, v9
s_nop 1
v_mfma_f32_16x16x32_bf16 v[12:15], v[152:155], v[56:59], v[12:15]
v_and_b32 v60, v45, v6
v_and_b32 v61, v45, v7
v_and_b32 v62, v45, v8
v_and_b32 v63, v45, v9
s_nop 1
v_mfma_f32_16x16x32_bf16 v[12:15], v[156:159], v[60:63], v[12:15]
s_waitcnt vmcnt(36)
v_mfma_f32_16x16x32_bf16 v[36:39], v[160:163], v[20:23], 0
v_mfma_f32_16x16x32_bf16 v[36:39], v[164:167], v[24:27], v[36:39]
v_mfma_f32_16x16x32_bf16 v[36:39], v[168:171], v[28:31], v[36:39]
v_mfma_f32_16x16x32_bf16 v[36:39], v[172:175], v[32:35], v[36:39]
s_nop 7
v_cvt_pk_bf16_f32 v40, v36, v37
v_cvt_pk_bf16_f32 v41, v38, v39
v_lshlrev_b32 v42, 16, v40
v_and_b32 v43, 0xffff0000, v40
v_lshlrev_b32 v44, 16, v41
v_and_b32 v45, 0xffff0000, v41
v_mul_f32 v42, 0x3db504f3, v42
v_mul_f32 v43, 0x3db504f3, v43
v_mul_f32 v44, 0x3db504f3, v44
v_mul_f32 v45, 0x3db504f3, v45
v_cvt_pk_bf16_f32 v40, v42, v43
v_cvt_pk_bf16_f32 v41, v44, v45
v_lshlrev_b32 v42, 16, v40
v_and_b32 v43, 0xffff0000, v40
v_lshlrev_b32 v44, 16, v41
v_and_b32 v45, 0xffff0000, v41
v_max3_f32 v46, v42, v43, v44
v_max3_f32 v46, v46, v45, v10
v_mov_b32 v47, v46
s_nop 1
v_permlane32_swap_b32 v46, v47
v_max_f32 v46, v46, v47
v_mov_b32 v47, v46
s_nop 1
v_permlane16_swap_b32 v46, v47
v_max_f32 v46, v46, v47
v_mov_b32 v10, v46
v_mul_f32 v47, s79, v46
v_sub_f32 v48, v11, v47
v_exp_f32 v48, v48
v_fma_f32 v42, v42, s79, -v47
v_fma_f32 v43, v43, s79, -v47
v_fma_f32 v44, v44, s79, -v47
v_fma_f32 v45, v45, s79, -v47
v_exp_f32 v42, v42
v_exp_f32 v43, v43
v_exp_f32 v44, v44
v_exp_f32 v45, v45
v_mov_b32 v11, v47
v_mul_f32 v12, v12, v48
v_mul_f32 v13, v13, v48
v_mul_f32 v14, v14, v48
v_mul_f32 v15, v15, v48
v_add_f32 v49, v42, v43
v_add_f32 v50, v44, v45
v_add_f32 v49, v49, v50
v_fma_f32 v16, v16, v48, v49
v_cvt_pk_bf16_f32 v42, v42, v42
v_cvt_pk_bf16_f32 v43, v43, v43
v_cvt_pk_bf16_f32 v44, v44, v44
v_cvt_pk_bf16_f32 v45, v45, v45
v_and_b32 v56, v42, v6
v_and_b32 v57, v42, v7
v_and_b32 v58, v42, v8
v_and_b32 v59, v42, v9
s_waitcnt vmcnt(32)
s_nop 0
v_mfma_f32_16x16x32_bf16 v[12:15], v[176:179], v[56:59], v[12:15]
v_and_b32 v60, v43, v6
v_and_b32 v61, v43, v7
v_and_b32 v62, v43, v8
v_and_b32 v63, v43, v9
s_nop 1
v_mfma_f32_16x16x32_bf16 v[12:15], v[180:183], v[60:63], v[12:15]
v_and_b32 v56, v44, v6
v_and_b32 v57, v44, v7
v_and_b32 v58, v44, v8
v_and_b32 v59, v44, v9
s_nop 1
v_mfma_f32_16x16x32_bf16 v[12:15], v[184:187], v[56:59], v[12:15]
v_and_b32 v60, v45, v6
v_and_b32 v61, v45, v7
v_and_b32 v62, v45, v8
v_and_b32 v63, v45, v9
s_nop 1
v_mfma_f32_16x16x32_bf16 v[12:15], v[188:191], v[60:63], v[12:15]
s_waitcnt vmcnt(28)
v_mfma_f32_16x16x32_bf16 v[36:39], v[192:195], v[20:23], 0
v_mfma_f32_16x16x32_bf16 v[36:39], v[196:199], v[24:27], v[36:39]
v_mfma_f32_16x16x32_bf16 v[36:39], v[200:203], v[28:31], v[36:39]
v_mfma_f32_16x16x32_bf16 v[36:39], v[204:207], v[32:35], v[36:39]
s_nop 7
v_cvt_pk_bf16_f32 v40, v36, v37
v_cvt_pk_bf16_f32 v41, v38, v39
v_lshlrev_b32 v42, 16, v40
v_and_b32 v43, 0xffff0000, v40
v_lshlrev_b32 v44, 16, v41
v_and_b32 v45, 0xffff0000, v41
v_mul_f32 v42, 0x3db504f3, v42
v_mul_f32 v43, 0x3db504f3, v43
v_mul_f32 v44, 0x3db504f3, v44
v_mul_f32 v45, 0x3db504f3, v45
v_cvt_pk_bf16_f32 v40, v42, v43
v_cvt_pk_bf16_f32 v41, v44, v45
v_lshlrev_b32 v42, 16, v40
v_and_b32 v43, 0xffff0000, v40
v_lshlrev_b32 v44, 16, v41
v_and_b32 v45, 0xffff0000, v41
v_max3_f32 v46, v42, v43, v44
v_max3_f32 v46, v46, v45, v10
v_mov_b32 v47, v46
s_nop 1
v_permlane32_swap_b32 v46, v47
v_max_f32 v46, v46, v47
v_mov_b32 v47, v46
s_nop 1
v_permlane16_swap_b32 v46, v47
v_max_f32 v46, v46, v47
v_mov_b32 v10, v46
v_mul_f32 v47, s79, v46
v_sub_f32 v48, v11, v47
v_exp_f32 v48, v48
v_fma_f32 v42, v42, s79, -v47
v_fma_f32 v43, v43, s79, -v47
v_fma_f32 v44, v44, s79, -v47
v_fma_f32 v45, v45, s79, -v47
v_exp_f32 v42, v42
v_exp_f32 v43, v43
v_exp_f32 v44, v44
v_exp_f32 v45, v45
v_mov_b32 v11, v47
v_mul_f32 v12, v12, v48
v_mul_f32 v13, v13, v48
v_mul_f32 v14, v14, v48
v_mul_f32 v15, v15, v48
v_add_f32 v49, v42, v43
v_add_f32 v50, v44, v45
v_add_f32 v49, v49, v50
v_fma_f32 v16, v16, v48, v49
v_cvt_pk_bf16_f32 v42, v42, v42
v_cvt_pk_bf16_f32 v43, v43, v43
v_cvt_pk_bf16_f32 v44, v44, v44
v_cvt_pk_bf16_f32 v45, v45, v45
v_and_b32 v56, v42, v6
v_and_b32 v57, v42, v7
v_and_b32 v58, v42, v8
v_and_b32 v59, v42, v9
s_waitcnt vmcnt(24)
s_nop 0
v_mfma_f32_16x16x32_bf16 v[12:15], v[208:211], v[56:59], v[12:15]
v_and_b32 v60, v43, v6
v_and_b32 v61, v43, v7
v_and_b32 v62, v43, v8
v_and_b32 v63, v43, v9
s_nop 1
v_mfma_f32_16x16x32_bf16 v[12:15], v[212:215], v[60:63], v[12:15]
v_and_b32 v56, v44, v6
v_and_b32 v57, v44, v7
v_and_b32 v58, v44, v8
v_and_b32 v59, v44, v9
s_nop 1
v_mfma_f32_16x16x32_bf16 v[12:15], v[216:219], v[56:59], v[12:15]
v_and_b32 v60, v45, v6
v_and_b32 v61, v45, v7
v_and_b32 v62, v45, v8
v_and_b32 v63, v45, v9
s_nop 1
v_mfma_f32_16x16x32_bf16 v[12:15], v[220:223], v[60:63], v[12:15]
s_waitcnt vmcnt(20)
v_mfma_f32_16x16x32_bf16 v[36:39], v[224:227], v[20:23], 0
v_mfma_f32_16x16x32_bf16 v[36:39], v[228:231], v[24:27], v[36:39]
v_mfma_f32_16x16x32_bf16 v[36:39], v[232:235], v[28:31], v[36:39]
v_mfma_f32_16x16x32_bf16 v[36:39], v[236:239], v[32:35], v[36:39]
s_nop 7
v_cvt_pk_bf16_f32 v40, v36, v37
v_cvt_pk_bf16_f32 v41, v38, v39
v_lshlrev_b32 v42, 16, v40
v_and_b32 v43, 0xffff0000, v40
v_lshlrev_b32 v44, 16, v41
v_and_b32 v45, 0xffff0000, v41
v_mul_f32 v42, 0x3db504f3, v42
v_mul_f32 v43, 0x3db504f3, v43
v_mul_f32 v44, 0x3db504f3, v44
v_mul_f32 v45, 0x3db504f3, v45
v_cvt_pk_bf16_f32 v40, v42, v43
v_cvt_pk_bf16_f32 v41, v44, v45
v_lshlrev_b32 v42, 16, v40
v_and_b32 v43, 0xffff0000, v40
v_lshlrev_b32 v44, 16, v41
v_and_b32 v45, 0xffff0000, v41
v_max3_f32 v46, v42, v43, v44
v_max3_f32 v46, v46, v45, v10
v_mov_b32 v47, v46
s_nop 1
v_permlane32_swap_b32 v46, v47
v_max_f32 v46, v46, v47
v_mov_b32 v47, v46
s_nop 1
v_permlane16_swap_b32 v46, v47
v_max_f32 v46, v46, v47
v_mov_b32 v10, v46
v_mul_f32 v47, s79, v46
v_sub_f32 v48, v11, v47
v_exp_f32 v48, v48
v_fma_f32 v42, v42, s79, -v47
v_fma_f32 v43, v43, s79, -v47
v_fma_f32 v44, v44, s79, -v47
v_fma_f32 v45, v45, s79, -v47
v_exp_f32 v42, v42
v_exp_f32 v43, v43
v_exp_f32 v44, v44
v_exp_f32 v45, v45
v_mov_b32 v11, v47
v_mul_f32 v12, v12, v48
v_mul_f32 v13, v13, v48
v_mul_f32 v14, v14, v48
v_mul_f32 v15, v15, v48
v_add_f32 v49, v42, v43
v_add_f32 v50, v44, v45
v_add_f32 v49, v49, v50
v_fma_f32 v16, v16, v48, v49
v_cvt_pk_bf16_f32 v42, v42, v42
v_cvt_pk_bf16_f32 v43, v43, v43
v_cvt_pk_bf16_f32 v44, v44, v44
v_cvt_pk_bf16_f32 v45, v45, v45
v_and_b32 v56, v42, v6
v_and_b32 v57, v42, v7
v_and_b32 v58, v42, v8
v_and_b32 v59, v42, v9
s_waitcnt vmcnt(16)
s_nop 0
v_mfma_f32_16x16x32_bf16 v[12:15], v[240:243], v[56:59], v[12:15]
v_and_b32 v60, v43, v6
v_and_b32 v61, v43, v7
v_and_b32 v62, v43, v8
v_and_b32 v63, v43, v9
s_nop 1
v_mfma_f32_16x16x32_bf16 v[12:15], v[244:247], v[60:63], v[12:15]
v_and_b32 v56, v44, v6
v_and_b32 v57, v44, v7
v_and_b32 v58, v44, v8
v_and_b32 v59, v44, v9
s_nop 1
v_mfma_f32_16x16x32_bf16 v[12:15], v[248:251], v[56:59], v[12:15]
v_and_b32 v60, v45, v6
v_and_b32 v61, v45, v7
v_and_b32 v62, v45, v8
v_and_b32 v63, v45, v9
s_nop 1
v_mfma_f32_16x16x32_bf16 v[12:15], v[252:255], v[60:63], v[12:15]
s_cmp_eq_u32 s82, 1
s_cselect_b32 s78, 64, 0x20000000
s_lshl_b32 s78, s78, 1
s_add_u32 s74, s78, 0
buffer_load_dwordx4 v[212:215], v54, s[56:59], s74 offen nt
s_add_u32 s74, s78, 9216
buffer_load_dwordx4 v[216:219], v54, s[56:59], s74 offen nt
s_add_u32 s74, s78, 0
buffer_load_dwordx4 v[220:223], v54, s[84:87], s74 offen nt
s_add_u32 s74, s78, 9216
buffer_load_dwordx4 v[224:227], v54, s[84:87], s74 offen nt
s_add_u32 s74, s78, 18432
buffer_load_dwordx4 v[228:231], v54, s[84:87], s74 offen nt
s_cmp_ge_u32 s70, s3
s_cbranch_scc1 L_exit
s_waitcnt vmcnt(17)
v_mfma_f32_16x16x32_bf16 v[36:39], v[64:67], v[20:23], 0
v_mfma_f32_16x16x32_bf16 v[36:39], v[68:71], v[24:27], v[36:39]
v_mfma_f32_16x16x32_bf16 v[36:39], v[72:75], v[28:31], v[36:39]
v_mfma_f32_16x16x32_bf16 v[36:39], v[76:79], v[32:35], v[36:39]
s_waitcnt lgkmcnt(0)
v_readfirstlane_b32 s70, v17
s_mov_b64 exec, 1
ds_add_rtn_u32 v17, v18, v19 offset:0
s_mov_b64 exec, -1
s_add_u32 s74, s70, s14
s_cmp_lt_u32 s70, 128
s_cselect_b32 s74, s74, s15
s_cmp_lt_u32 s70, s3
s_cselect_b32 s74, s74, 0x200
s_lshl_b32 s80, s74, 12
buffer_load_dwordx4 v[64:67], v3, s[28:31], s80 offen offset:0 nt
buffer_load_dwordx4 v[68:71], v3, s[28:31], s80 offen offset:64 nt
buffer_load_dwordx4 v[72:75], v3, s[28:31], s80 offen offset:128 nt
buffer_load_dwordx4 v[76:79], v3, s[28:31], s80 offen offset:192 nt
v_cvt_pk_bf16_f32 v40, v36, v37
v_cvt_pk_bf16_f32 v41, v38, v39
v_lshlrev_b32 v42, 16, v40
v_and_b32 v43, 0xffff0000, v40
v_lshlrev_b32 v44, 16, v41
v_and_b32 v45, 0xffff0000, v41
v_mul_f32 v42, 0x3db504f3, v42
v_mul_f32 v43, 0x3db504f3, v43
v_mul_f32 v44, 0x3db504f3, v44
v_mul_f32 v45, 0x3db504f3, v45
v_cvt_pk_bf16_f32 v40, v42, v43
v_cvt_pk_bf16_f32 v41, v44, v45
v_lshlrev_b32 v42, 16, v40
v_and_b32 v43, 0xffff0000, v40
v_lshlrev_b32 v44, 16, v41
v_and_b32 v45, 0xffff0000, v41
v_max3_f32 v46, v42, v43, v44
v_max3_f32 v46, v46, v45, v10
v_mov_b32 v47, v46
s_nop 1
v_permlane32_swap_b32 v46, v47
v_max_f32 v46, v46, v47
v_mov_b32 v47, v46
s_nop 1
v_permlane16_swap_b32 v46, v47
v_max_f32 v46, v46, v47
v_mov_b32 v10, v46
v_mul_f32 v47, s79, v46
v_sub_f32 v48, v11, v47
v_exp_f32 v48, v48
v_fma_f32 v42, v42, s79, -v47
v_fma_f32 v43, v43, s79, -v47
v_fma_f32 v44, v44, s79, -v47
v_fma_f32 v45, v45, s79, -v47
v_exp_f32 v42, v42
v_exp_f32 v43, v43
v_exp_f32 v44, v44
v_exp_f32 v45, v45
v_mov_b32 v11, v47
v_mul_f32 v12, v12, v48
v_mul_f32 v13, v13, v48
v_mul_f32 v14, v14, v48
v_mul_f32 v15, v15, v48
v_add_f32 v49, v42, v43
v_add_f32 v50, v44, v45
v_add_f32 v49, v49, v50
v_fma_f32 v16, v16, v48, v49
v_cvt_pk_bf16_f32 v42, v42, v42
v_cvt_pk_bf16_f32 v43, v43, v43
v_cvt_pk_bf16_f32 v44, v44, v44
v_cvt_pk_bf16_f32 v45, v45, v45
v_and_b32 v56, v42, v6
v_and_b32 v57, v42, v7
v_and_b32 v58, v42, v8
v_and_b32 v59, v42, v9
s_waitcnt vmcnt(17)
s_nop 0
v_mfma_f32_16x16x32_bf16 v[12:15], v[80:83], v[56:59], v[12:15]
v_and_b32 v60, v43, v6
v_and_b32 v61, v43, v7
v_and_b32 v62, v43, v8
v_and_b32 v63, v43, v9
s_nop 1
v_mfma_f32_16x16x32_bf16 v[12:15], v[84:87], v[60:63], v[12:15]
v_and_b32 v56, v44, v6
v_and_b32 v57, v44, v7
v_and_b32 v58, v44, v8
v_and_b32 v59, v44, v9
s_nop 1
v_mfma_f32_16x16x32_bf16 v[12:15], v[88:91], v[56:59], v[12:15]
v_and_b32 v60, v45, v6
v_and_b32 v61, v45, v7
v_and_b32 v62, v45, v8
v_and_b32 v63, v45, v9
s_nop 1
v_mfma_f32_16x16x32_bf16 v[12:15], v[92:95], v[60:63], v[12:15]
buffer_load_dwordx4 v[80:83], v4, s[32:35], s80 offen offset:0 nt
buffer_load_dwordx4 v[84:87], v4, s[32:35], s80 offen offset:1024 nt
buffer_load_dwordx4 v[88:91], v4, s[32:35], s80 offen offset:2048 nt
buffer_load_dwordx4 v[92:95], v4, s[32:35], s80 offen offset:3072 nt
s_cmp_ge_u32 s71, s3
s_cbranch_scc1 L_exit
s_waitcnt vmcnt(17)
v_mfma_f32_16x16x32_bf16 v[36:39], v[96:99], v[20:23], 0
v_mfma_f32_16x16x32_bf16 v[36:39], v[100:103], v[24:27], v[36:39]
v_mfma_f32_16x16x32_bf16 v[36:39], v[104:107], v[28:31], v[36:39]
v_mfma_f32_16x16x32_bf16 v[36:39], v[108:111], v[32:35], v[36:39]
s_waitcnt lgkmcnt(0)
v_readfirstlane_b32 s71, v17
s_mov_b64 exec, 1
ds_add_rtn_u32 v17, v18, v19 offset:0
s_mov_b64 exec, -1
s_add_u32 s74, s71, s14
s_cmp_lt_u32 s71, 128
s_cselect_b32 s74, s74, s15
s_cmp_lt_u32 s71, s3
s_cselect_b32 s74, s74, 0x200
s_lshl_b32 s80, s74, 12
buffer_load_dwordx4 v[96:99], v3, s[28:31], s80 offen offset:0 nt
buffer_load_dwordx4 v[100:103], v3, s[28:31], s80 offen offset:64 nt
buffer_load_dwordx4 v[104:107], v3, s[28:31], s80 offen offset:128 nt
buffer_load_dwordx4 v[108:111], v3, s[28:31], s80 offen offset:192 nt
v_cvt_pk_bf16_f32 v40, v36, v37
v_cvt_pk_bf16_f32 v41, v38, v39
v_lshlrev_b32 v42, 16, v40
v_and_b32 v43, 0xffff0000, v40
v_lshlrev_b32 v44, 16, v41
v_and_b32 v45, 0xffff0000, v41
v_mul_f32 v42, 0x3db504f3, v42
v_mul_f32 v43, 0x3db504f3, v43
v_mul_f32 v44, 0x3db504f3, v44
v_mul_f32 v45, 0x3db504f3, v45
v_cvt_pk_bf16_f32 v40, v42, v43
v_cvt_pk_bf16_f32 v41, v44, v45
v_lshlrev_b32 v42, 16, v40
v_and_b32 v43, 0xffff0000, v40
v_lshlrev_b32 v44, 16, v41
v_and_b32 v45, 0xffff0000, v41
v_max3_f32 v46, v42, v43, v44
v_max3_f32 v46, v46, v45, v10
v_mov_b32 v47, v46
s_nop 1
v_permlane32_swap_b32 v46, v47
v_max_f32 v46, v46, v47
v_mov_b32 v47, v46
s_nop 1
v_permlane16_swap_b32 v46, v47
v_max_f32 v46, v46, v47
v_mov_b32 v10, v46
v_mul_f32 v47, s79, v46
v_sub_f32 v48, v11, v47
v_exp_f32 v48, v48
v_fma_f32 v42, v42, s79, -v47
v_fma_f32 v43, v43, s79, -v47
v_fma_f32 v44, v44, s79, -v47
v_fma_f32 v45, v45, s79, -v47
v_exp_f32 v42, v42
v_exp_f32 v43, v43
v_exp_f32 v44, v44
v_exp_f32 v45, v45
v_mov_b32 v11, v47
v_mul_f32 v12, v12, v48
v_mul_f32 v13, v13, v48
v_mul_f32 v14, v14, v48
v_mul_f32 v15, v15, v48
v_add_f32 v49, v42, v43
v_add_f32 v50, v44, v45
v_add_f32 v49, v49, v50
v_fma_f32 v16, v16, v48, v49
v_cvt_pk_bf16_f32 v42, v42, v42
v_cvt_pk_bf16_f32 v43, v43, v43
v_cvt_pk_bf16_f32 v44, v44, v44
v_cvt_pk_bf16_f32 v45, v45, v45
v_and_b32 v56, v42, v6
v_and_b32 v57, v42, v7
v_and_b32 v58, v42, v8
v_and_b32 v59, v42, v9
s_waitcnt vmcnt(17)
s_nop 0
v_mfma_f32_16x16x32_bf16 v[12:15], v[112:115], v[56:59], v[12:15]
v_and_b32 v60, v43, v6
v_and_b32 v61, v43, v7
v_and_b32 v62, v43, v8
v_and_b32 v63, v43, v9
s_nop 1
v_mfma_f32_16x16x32_bf16 v[12:15], v[116:119], v[60:63], v[12:15]
v_and_b32 v56, v44, v6
v_and_b32 v57, v44, v7
v_and_b32 v58, v44, v8
v_and_b32 v59, v44, v9
s_nop 1
v_mfma_f32_16x16x32_bf16 v[12:15], v[120:123], v[56:59], v[12:15]
v_and_b32 v60, v45, v6
v_and_b32 v61, v45, v7
v_and_b32 v62, v45, v8
v_and_b32 v63, v45, v9
s_nop 1
v_mfma_f32_16x16x32_bf16 v[12:15], v[124:127], v[60:63], v[12:15]
buffer_load_dwordx4 v[112:115], v4, s[32:35], s80 offen offset:0 nt
buffer_load_dwordx4 v[116:119], v4, s[32:35], s80 offen offset:1024 nt
buffer_load_dwordx4 v[120:123], v4, s[32:35], s80 offen offset:2048 nt
buffer_load_dwordx4 v[124:127], v4, s[32:35], s80 offen offset:3072 nt
L_loop:
s_cmp_ge_u32 s70, s3
s_cbranch_scc1 L_exit
s_waitcnt vmcnt(12)
v_mfma_f32_16x16x32_bf16 v[36:39], v[64:67], v[20:23], 0
v_mfma_f32_16x16x32_bf16 v[36:39], v[68:71], v[24:27], v[36:39]
v_mfma_f32_16x16x32_bf16 v[36:39], v[72:75], v[28:31], v[36:39]
v_mfma_f32_16x16x32_bf16 v[36:39], v[76:79], v[32:35], v[36:39]
s_waitcnt lgkmcnt(0)
v_readfirstlane_b32 s70, v17
s_mov_b64 exec, 1
ds_add_rtn_u32 v17, v18, v19 offset:0
s_mov_b64 exec, -1
s_add_u32 s74, s70, s14
s_cmp_lt_u32 s70, 128
s_cselect_b32 s74, s74, s15
s_cmp_lt_u32 s70, s3
s_cselect_b32 s74, s74, 0x200
s_lshl_b32 s80, s74, 12
s_cmp_lt_u32 s70, s3
s_cbranch_scc1 L_rf2182n
s_cmp_eq_u32 s81, 0
s_cbranch_scc0 L_rf2182n
s_mov_b32 s74, 0
buffer_load_dwordx4 v[192:195], v54, s[56:59], s74 offen nt
s_mov_b32 s74, 9216
buffer_load_dwordx4 v[196:199], v54, s[56:59], s74 offen nt
s_mov_b32 s74, 0
buffer_load_dwordx4 v[200:203], v54, s[84:87], s74 offen nt
s_mov_b32 s74, 9216
buffer_load_dwordx4 v[204:207], v54, s[84:87], s74 offen nt
s_mov_b32 s81, 1
s_branch L_rf2182e
L_rf2182n:
buffer_load_dwordx4 v[64:67], v3, s[28:31], s80 offen offset:0 nt
buffer_load_dwordx4 v[68:71], v3, s[28:31], s80 offen offset:64 nt
buffer_load_dwordx4 v[72:75], v3, s[28:31], s80 offen offset:128 nt
buffer_load_dwordx4 v[76:79], v3, s[28:31], s80 offen offset:192 nt
L_rf2182e:
v_cvt_pk_bf16_f32 v40, v36, v37
v_cvt_pk_bf16_f32 v41, v38, v39
v_lshlrev_b32 v42, 16, v40
v_and_b32 v43, 0xffff0000, v40
v_lshlrev_b32 v44, 16, v41
v_and_b32 v45, 0xffff0000, v41
v_mul_f32 v42, 0x3db504f3, v42
v_mul_f32 v43, 0x3db504f3, v43
v_mul_f32 v44, 0x3db504f3, v44
v_mul_f32 v45, 0x3db504f3, v45
v_cvt_pk_bf16_f32 v40, v42, v43
v_cvt_pk_bf16_f32 v41, v44, v45
v_lshlrev_b32 v42, 16, v40
v_and_b32 v43, 0xffff0000, v40
v_lshlrev_b32 v44, 16, v41
v_and_b32 v45, 0xffff0000, v41
v_max3_f32 v46, v42, v43, v44
v_max3_f32 v46, v46, v45, v10
v_mov_b32 v47, v46
s_nop 1
v_permlane32_swap_b32 v46, v47
v_max_f32 v46, v46, v47
v_mov_b32 v47, v46
s_nop 1
v_permlane16_swap_b32 v46, v47
v_max_f32 v46, v46, v47
v_mov_b32 v10, v46
v_mul_f32 v47, s79, v46
v_sub_f32 v48, v11, v47
v_exp_f32 v48, v48
v_fma_f32 v42, v42, s79, -v47
v_fma_f32 v43, v43, s79, -v47
v_fma_f32 v44, v44, s79, -v47
v_fma_f32 v45, v45, s79, -v47
v_exp_f32 v42, v42
v_exp_f32 v43, v43
v_exp_f32 v44, v44
v_exp_f32 v45, v45
v_mov_b32 v11, v47
v_mul_f32 v12, v12, v48
v_mul_f32 v13, v13, v48
v_mul_f32 v14, v14, v48
v_mul_f32 v15, v15, v48
v_add_f32 v49, v42, v43
v_add_f32 v50, v44, v45
v_add_f32 v49, v49, v50
v_fma_f32 v16, v16, v48, v49
v_cvt_pk_bf16_f32 v42, v42, v42
v_cvt_pk_bf16_f32 v43, v43, v43
v_cvt_pk_bf16_f32 v44, v44, v44
v_cvt_pk_bf16_f32 v45, v45, v45
v_and_b32 v56, v42, v6
v_and_b32 v57, v42, v7
v_and_b32 v58, v42, v8
v_and_b32 v59, v42, v9
s_waitcnt vmcnt(12)
s_nop 0
v_mfma_f32_16x16x32_bf16 v[12:15], v[80:83], v[56:59], v[12:15]
v_and_b32 v60, v43, v6
v_and_b32 v61, v43, v7
v_and_b32 v62, v43, v8
v_and_b32 v63, v43, v9
s_nop 1
v_mfma_f32_16x16x32_bf16 v[12:15], v[84:87], v[60:63], v[12:15]
v_and_b32 v56, v44, v6
v_and_b32 v57, v44, v7
v_and_b32 v58, v44, v8
v_and_b32 v59, v44, v9
s_nop 1
v_mfma_f32_16x16x32_bf16 v[12:15], v[88:91], v[56:59], v[12:15]
v_and_b32 v60, v45, v6
v_and_b32 v61, v45, v7
v_and_b32 v62, v45, v8
v_and_b32 v63, v45, v9
s_nop 1
v_mfma_f32_16x16x32_bf16 v[12:15], v[92:95], v[60:63], v[12:15]
s_cmp_eq_u32 s81, 1
s_cbranch_scc0 L_rf2289n
s_mov_b32 s74, 18432
buffer_load_dwordx4 v[208:211], v54, s[84:87], s74 offen nt
s_mov_b32 s81, 2
buffer_load_dwordx4 v[84:87], v4, s[32:35], s80 offen offset:1024 nt
buffer_load_dwordx4 v[88:91], v4, s[32:35], s80 offen offset:2048 nt
buffer_load_dwordx4 v[92:95], v4, s[32:35], s80 offen offset:3072 nt
s_branch L_rf2289e
L_rf2289n:
buffer_load_dwordx4 v[80:83], v4, s[32:35], s80 offen offset:0 nt
buffer_load_dwordx4 v[84:87], v4, s[32:35], s80 offen offset:1024 nt
buffer_load_dwordx4 v[88:91], v4, s[32:35], s80 offen offset:2048 nt
buffer_load_dwordx4 v[92:95], v4, s[32:35], s80 offen offset:3072 nt
L_rf2289e:
s_cmp_ge_u32 s71, s3
s_cbranch_scc1 L_exit
s_waitcnt vmcnt(12)
v_mfma_f32_16x16x32_bf16 v[36:39], v[96:99], v[20:23], 0
v_mfma_f32_16x16x32_bf16 v[36:39], v[100:103], v[24:27], v[36:39]
v_mfma_f32_16x16x32_bf16 v[36:39], v[104:107], v[28:31], v[36:39]
v_mfma_f32_16x16x32_bf16 v[36:39], v[108:111], v[32:35], v[36:39]
s_waitcnt lgkmcnt(0)
v_readfirstlane_b32 s71, v17
s_mov_b64 exec, 1
ds_add_rtn_u32 v17, v18, v19 offset:0
s_mov_b64 exec, -1
s_add_u32 s74, s71, s14
s_cmp_lt_u32 s71, 128
s_cselect_b32 s74, s74, s15
s_cmp_lt_u32 s71, s3
s_cselect_b32 s74, s74, 0x200
s_lshl_b32 s80, s74, 12
s_cmp_lt_u32 s71, s3
s_cbranch_scc1 L_rf2311n
s_cmp_eq_u32 s81, 0
s_cbranch_scc0 L_rf2311n
s_mov_b32 s74, 0
buffer_load_dwordx4 v[192:195], v54, s[56:59], s74 offen nt
s_mov_b32 s74, 9216
buffer_load_dwordx4 v[196:199], v54, s[56:59], s74 offen nt
s_mov_b32 s74, 0
buffer_load_dwordx4 v[200:203], v54, s[84:87], s74 offen nt
s_mov_b32 s74, 9216
buffer_load_dwordx4 v[204:207], v54, s[84:87], s74 offen nt
s_mov_b32 s81, 1
s_branch L_rf2311e
L_rf2311n:
buffer_load_dwordx4 v[96:99], v3, s[28:31], s80 offen offset:0 nt
buffer_load_dwordx4 v[100:103], v3, s[28:31], s80 offen offset:64 nt
buffer_load_dwordx4 v[104:107], v3, s[28:31], s80 offen offset:128 nt
buffer_load_dwordx4 v[108:111], v3, s[28:31], s80 offen offset:192 nt
L_rf2311e:
v_cvt_pk_bf16_f32 v40, v36, v37
v_cvt_pk_bf16_f32 v41, v38, v39
v_lshlrev_b32 v42, 16, v40
v_and_b32 v43, 0xffff0000, v40
v_lshlrev_b32 v44, 16, v41
v_and_b32 v45, 0xffff0000, v41
v_mul_f32 v42, 0x3db504f3, v42
v_mul_f32 v43, 0x3db504f3, v43
v_mul_f32 v44, 0x3db504f3, v44
v_mul_f32 v45, 0x3db504f3, v45
v_cvt_pk_bf16_f32 v40, v42, v43
v_cvt_pk_bf16_f32 v41, v44, v45
v_lshlrev_b32 v42, 16, v40
v_and_b32 v43, 0xffff0000, v40
v_lshlrev_b32 v44, 16, v41
v_and_b32 v45, 0xffff0000, v41
v_max3_f32 v46, v42, v43, v44
v_max3_f32 v46, v46, v45, v10
v_mov_b32 v47, v46
s_nop 1
v_permlane32_swap_b32 v46, v47
v_max_f32 v46, v46, v47
v_mov_b32 v47, v46
s_nop 1
v_permlane16_swap_b32 v46, v47
v_max_f32 v46, v46, v47
v_mov_b32 v10, v46
v_mul_f32 v47, s79, v46
v_sub_f32 v48, v11, v47
v_exp_f32 v48, v48
v_fma_f32 v42, v42, s79, -v47
v_fma_f32 v43, v43, s79, -v47
v_fma_f32 v44, v44, s79, -v47
v_fma_f32 v45, v45, s79, -v47
v_exp_f32 v42, v42
v_exp_f32 v43, v43
v_exp_f32 v44, v44
v_exp_f32 v45, v45
v_mov_b32 v11, v47
v_mul_f32 v12, v12, v48
v_mul_f32 v13, v13, v48
v_mul_f32 v14, v14, v48
v_mul_f32 v15, v15, v48
v_add_f32 v49, v42, v43
v_add_f32 v50, v44, v45
v_add_f32 v49, v49, v50
v_fma_f32 v16, v16, v48, v49
v_cvt_pk_bf16_f32 v42, v42, v42
v_cvt_pk_bf16_f32 v43, v43, v43
v_cvt_pk_bf16_f32 v44, v44, v44
v_cvt_pk_bf16_f32 v45, v45, v45
v_and_b32 v56, v42, v6
v_and_b32 v57, v42, v7
v_and_b32 v58, v42, v8
v_and_b32 v59, v42, v9
s_waitcnt vmcnt(12)
s_nop 0
v_mfma_f32_16x16x32_bf16 v[12:15], v[112:115], v[56:59], v[12:15]
v_and_b32 v60, v43, v6
v_and_b32 v61, v43, v7
v_and_b32 v62, v43, v8
v_and_b32 v63, v43, v9
s_nop 1
v_mfma_f32_16x16x32_bf16 v[12:15], v[116:119], v[60:63], v[12:15]
v_and_b32 v56, v44, v6
v_and_b32 v57, v44, v7
v_and_b32 v58, v44, v8
v_and_b32 v59, v44, v9
s_nop 1
v_mfma_f32_16x16x32_bf16 v[12:15], v[120:123], v[56:59], v[12:15]
v_and_b32 v60, v45, v6
v_and_b32 v61, v45, v7
v_and_b32 v62, v45, v8
v_and_b32 v63, v45, v9
s_nop 1
v_mfma_f32_16x16x32_bf16 v[12:15], v[124:127], v[60:63], v[12:15]
s_cmp_eq_u32 s81, 1
s_cbranch_scc0 L_rf2418n
s_mov_b32 s74, 18432
buffer_load_dwordx4 v[208:211], v54, s[84:87], s74 offen nt
s_mov_b32 s81, 2
buffer_load_dwordx4 v[116:119], v4, s[32:35], s80 offen offset:1024 nt
buffer_load_dwordx4 v[120:123], v4, s[32:35], s80 offen offset:2048 nt
buffer_load_dwordx4 v[124:127], v4, s[32:35], s80 offen offset:3072 nt
s_branch L_rf2418e
L_rf2418n:
buffer_load_dwordx4 v[112:115], v4, s[32:35], s80 offen offset:0 nt
buffer_load_dwordx4 v[116:119], v4, s[32:35], s80 offen offset:1024 nt
buffer_load_dwordx4 v[120:123], v4, s[32:35], s80 offen offset:2048 nt
buffer_load_dwordx4 v[124:127], v4, s[32:35], s80 offen offset:3072 nt
L_rf2418e:
s_branch L_loop
L_exit:
s_cmp_eq_u32 s81, 0
s_cbranch_scc0 L_wdone
s_mov_b32 s74, 0
buffer_load_dwordx4 v[192:195], v54, s[56:59], s74 offen nt
s_mov_b32 s74, 9216
buffer_load_dwordx4 v[196:199], v54, s[56:59], s74 offen nt
s_mov_b32 s74, 0
buffer_load_dwordx4 v[200:203], v54, s[84:87], s74 offen nt
s_mov_b32 s74, 9216
buffer_load_dwordx4 v[204:207], v54, s[84:87], s74 offen nt
s_mov_b32 s74, 18432
buffer_load_dwordx4 v[208:211], v54, s[84:87], s74 offen nt
L_wdone:
v_mov_b32 v40, v16
s_nop 1
v_permlane32_swap_b32 v16, v40
v_add_f32 v16, v16, v40
v_mov_b32 v40, v16
s_nop 1
v_permlane16_swap_b32 v16, v40
v_add_f32 v16, v16, v40
v_mov_b32 v41, v16
v_mov_b32 v40, v10
s_mul_i32 s74, s65, 528
v_lshl_add_u32 v5, v1, 5, v2
v_lshlrev_b32 v5, 2, v5
v_add_u32 v5, s74, v5
v_mov_b32 v42, s74
v_mov_b32 v19, s66
s_mov_b32 exec_lo, 0x00ff00ff
s_mov_b32 exec_hi, 0x00ff00ff
ds_write_b32 v5, v12 offset:8192
ds_write_b32 v5, v13 offset:8224
ds_write_b32 v5, v14 offset:8256
ds_write_b32 v5, v15 offset:8288
s_mov_b64 exec, 1
ds_write_b64 v42, v[40:41] offset:8704
s_mov_b64 exec, -1
L_bar2:
v_mov_b32 v3, 0xff
v_mov_b32 v55, 0xffffff00
v_and_b32 v8, 1, v0
v_lshlrev_b32 v8, 4, v8
v_lshrrev_b32 v20, v8, v19
v_lshrrev_b32 v21, 8, v20
v_and_b32 v8, 3, v0
v_lshlrev_b32 v8, 3, v8
v_lshrrev_b32 v22, v8, v19
v_lshrrev_b32 v23, 8, v19
v_lshrrev_b32 v24, 16, v19
v_lshrrev_b32 v25, 24, v19
v_lshrrev_b32 v6, 3, v0
v_lshlrev_b32 v6, 10, v6
v_and_b32 v8, 7, v0
v_lshl_add_u32 v5, v8, 3, v6
v_lshl_add_u32 v6, v8, 4, v6
v_mul_u32_u24 v7, 18432, v1
v_lshl_add_u32 v7, v2, 3, v7
v_lshrrev_b32 v8, 5, v0
v_lshl_add_u32 v8, v8, 4, v2
v_cmp_gt_u32 vcc, 9, v8
v_mov_b32 v8, 0x40000000
s_nop 0
v_cndmask_b32 v7, v8, v7, vcc
v_cndmask_b32 v9, 0, -1, vcc
v_bfe_u32 v8, v0, 2, 1
v_lshlrev_b32 v10, 2, v1
v_lshl_add_u32 v11, v8, 6, v10
v_lshl_add_u32 v10, v8, 7, v10
v_lshrrev_b32 v8, 3, v2
v_mov_b32 v12, 0x02020202
v_mul_lo_u32 v12, v12, v8
v_add_u32 v12, 0x01000100, v12
v_lshlrev_b32 v13, 10, v8
v_bfe_u32 v8, v0, 2, 1
v_lshl_add_u32 v13, v8, 8, v13
v_and_b32 v8, 1, v1
v_lshl_add_u32 v13, v8, 7, v13
v_and_b32 v8, 3, v0
v_lshl_add_u32 v13, v8, 4, v13
v_lshrrev_b32 v26, 5, v0
v_lshlrev_b32 v26, 7, v26
v_bfe_u32 v27, v0, 2, 1
v_lshl_add_u32 v26, v27, 6, v26
v_lshl_add_u32 v26, v8, 4, v26
v_bfe_u32 v27, v0, 3, 2
v_lshl_add_u32 v26, v27, 2, v26
s_lshl_b32 s74, s64, 11
v_add_u32 v13, s74, v13
v_and_b32 v8, 1, v0
v_lshlrev_b32 v8, 4, v8
v_mov_b32 v48, 0xffff
v_lshlrev_b32 v48, v8, v48
v_bfe_u32 v8, v0, 1, 1
v_cmp_eq_u32 vcc, 0, v8
s_nop 1
v_cndmask_b32 v14, 0, v48, vcc
v_cmp_eq_u32 vcc, 1, v8
s_nop 1
v_cndmask_b32 v15, 0, v48, vcc
s_lshl_b32 s96, s60, 13
s_add_u32 s96, s96, 262144
s_lshl_b32 s97, s64, 6
s_add_u32 s97, s97, s96
s_mul_i32 s98, s60, 72
s_mul_i32 s77, s64, 9
s_add_u32 s98, s98, s77
s_lshl_b32 s98, s98, 3
s_add_u32 s98, s98, 524288
v_lshlrev_b32 v4, 3, v0
v_lshlrev_b32 v16, 4, v0
v_lshlrev_b32 v17, 2, v0
s_waitcnt lgkmcnt(0)
s_barrier
s_cmp_lg_u32 s64, 4
s_cbranch_scc1 L_nocomb
ds_read_b64 v[80:81], v18 offset:8704
ds_read_b64 v[82:83], v18 offset:9232
ds_read_b64 v[84:85], v18 offset:9760
ds_read_b64 v[86:87], v18 offset:10288
ds_read_b64 v[64:65], v4 offset:8192
ds_read_b64 v[66:67], v4 offset:8720
ds_read_b64 v[68:69], v4 offset:9248
ds_read_b64 v[70:71], v4 offset:9776
s_lshl_b32 s74, s68, 10
s_add_u32 s74, s74, 262144
s_waitcnt lgkmcnt(4)
v_max_f32 v40, v80, v82
v_max_f32 v40, v40, v84
v_max_f32 v40, v40, v86
v_mul_f32 v41, s79, v40
v_mul_f32 v80, s79, v80
v_sub_f32 v80, v80, v41
v_exp_f32 v80, v80
v_mul_f32 v82, s79, v82
v_sub_f32 v82, v82, v41
v_exp_f32 v82, v82
v_mul_f32 v84, s79, v84
v_sub_f32 v84, v84, v41
v_exp_f32 v84, v84
v_mul_f32 v86, s79, v86
v_sub_f32 v86, v86, v41
v_exp_f32 v86, v86
v_bfi_b32 v48, v3, v19, v40
v_bfi_b32 v50, v3, v24, v40
v_mul_f32 v42, v80, v81
v_fmac_f32 v42, v82, v83
v_fmac_f32 v42, v84, v85
v_fmac_f32 v42, v86, v87
s_waitcnt lgkmcnt(0)
v_mul_f32 v44, v80, v64
v_mul_f32 v45, v80, v65
v_fmac_f32 v44, v82, v66
v_fmac_f32 v45, v82, v67
v_fmac_f32 v44, v84, v68
v_fmac_f32 v45, v84, v69
v_fmac_f32 v44, v86, v70
v_fmac_f32 v45, v86, v71
v_add_u32 v44, 0x80, v44
v_add_u32 v45, 0x80, v45
v_add_u32 v42, 0x80, v42
v_bfi_b32 v44, v3, v20, v44
v_bfi_b32 v45, v3, v21, v45
v_bfi_b32 v49, v3, v23, v42
v_bfi_b32 v51, v3, v25, v42
s_cmp_eq_u32 s67, 1
s_cbranch_scc1 L_sp2600f
buffer_store_dwordx2 v[44:45], v4, s[36:39], s74 offen sc1
s_mov_b64 exec, 0xff
buffer_store_dwordx4 v[48:51], v16, s[36:39], s74 offen offset:512 sc1
s_mov_b64 exec, -1
s_branch L_sp2600e
L_sp2600f:
buffer_store_dwordx2 v[44:45], v4, s[36:39], s74 offen
s_mov_b64 exec, 0xff
buffer_store_dwordx4 v[48:51], v16, s[36:39], s74 offen offset:512
s_mov_b64 exec, -1
L_sp2600e:
s_nop 1
L_nocomb:
s_mov_b32 s69, 40000
L_hmpoll:
buffer_load_dwordx2 v[72:73], v7, s[36:39], s98 offen sc1
s_cmp_eq_u32 s67, 1
s_cbranch_scc1 L_lp2618f
buffer_load_dwordx2 v[64:65], v5, s[36:39], s97 offen sc1
buffer_load_dwordx4 v[68:71], v6, s[36:39], s96 offen offset:512 sc1
s_branch L_lp2618e
L_lp2618f:
buffer_load_dwordx2 v[64:65], v5, s[36:39], s97 offen nt
buffer_load_dwordx4 v[68:71], v6, s[36:39], s96 offen offset:512 nt
L_lp2618e:
s_waitcnt vmcnt(2)
v_xor_b32 v40, v19, v73
v_and_b32 v40, v40, v9
v_cmp_ne_u32 vcc, 0, v40
s_cbranch_vccz L_hmpolld
s_sub_u32 s69, s69, 1
s_cmp_eq_u32 s69, 0
s_cbranch_scc0 L_hmpoll
L_hmpolld:
ds_bpermute_b32 v40, v11, v72 offset:0
ds_bpermute_b32 v41, v11, v72 offset:16
ds_bpermute_b32 v42, v11, v72 offset:32
s_waitcnt lgkmcnt(2)
v_perm_b32 v40, v40, v40, v12
v_and_b32 v84, v40, v14
v_and_b32 v85, v40, v15
s_waitcnt lgkmcnt(1)
v_perm_b32 v41, v41, v41, v12
v_and_b32 v86, v41, v14
v_and_b32 v87, v41, v15
s_waitcnt lgkmcnt(0)
v_perm_b32 v42, v42, v42, v12
v_and_b32 v88, v42, v14
v_and_b32 v89, v42, v15
s_nop 0
v_mfma_f32_16x16x16_bf16 v[104:107], v[200:201], v[84:85], 0
v_mfma_f32_16x16x16_bf16 v[108:111], v[202:203], v[84:85], 0
v_mfma_f32_16x16x16_bf16 v[104:107], v[204:205], v[86:87], v[104:107]
v_mfma_f32_16x16x16_bf16 v[108:111], v[206:207], v[86:87], v[108:111]
v_mfma_f32_16x16x16_bf16 v[104:107], v[208:209], v[88:89], v[104:107]
v_mfma_f32_16x16x16_bf16 v[108:111], v[210:211], v[88:89], v[108:111]
s_cmp_eq_u32 s82, 1
s_cbranch_scc0 L_ndBa
v_mfma_f32_16x16x16_bf16 v[120:123], v[220:221], v[84:85], 0
v_mfma_f32_16x16x16_bf16 v[124:127], v[222:223], v[84:85], 0
v_mfma_f32_16x16x16_bf16 v[120:123], v[224:225], v[86:87], v[120:123]
v_mfma_f32_16x16x16_bf16 v[124:127], v[226:227], v[86:87], v[124:127]
v_mfma_f32_16x16x16_bf16 v[120:123], v[228:229], v[88:89], v[120:123]
v_mfma_f32_16x16x16_bf16 v[124:127], v[230:231], v[88:89], v[124:127]
L_ndBa:
s_mov_b32 exec_lo, 0x00ff00ff
s_mov_b32 exec_hi, 0xff00ff00
s_nop 5
ds_write_b128 v13, v[104:107] offset:18560
ds_write_b128 v13, v[108:111] offset:18624
s_cbranch_scc0 L_ndBb
s_nop 1
ds_write_b128 v13, v[120:123] offset:34944
ds_write_b128 v13, v[124:127] offset:35008
L_ndBb:
s_mov_b64 exec, -1
s_lshr_b32 s74, s64, 2
s_and_b32 s75, s64, 1
s_bfe_u32 s76, s64, 0x10001
s_lshl_b32 s77, s74, 14
s_lshl_b32 s78, s76, 9
s_add_u32 s77, s77, s78
s_lshl_b32 s78, s75, 8
s_add_u32 s77, s77, s78
v_add_u32 v26, s77, v26
s_cmp_eq_u32 s74, 0
s_cselect_b32 s77, s61, 8
s_mul_i32 s78, s75, 9
s_add_u32 s77, s77, s78
s_lshl_b32 s77, s77, 5
s_add_u32 s77, s77, s60
s_lshl_b32 s77, s77, 1
s_add_u32 s77, s77, s76
s_lshl_b32 s77, s77, 8
s_add_u32 s77, s77, 589824
s_mov_b32 s69, 40000
s_branch L_h1chk
L_h1poll:
s_cmp_eq_u32 s67, 1
s_cbranch_scc1 L_lp2700f
buffer_load_dwordx2 v[64:65], v5, s[36:39], s97 offen sc1
buffer_load_dwordx4 v[68:71], v6, s[36:39], s96 offen offset:512 sc1
s_branch L_lp2700e
L_lp2700f:
buffer_load_dwordx2 v[64:65], v5, s[36:39], s97 offen nt
buffer_load_dwordx4 v[68:71], v6, s[36:39], s96 offen offset:512 nt
L_lp2700e:
L_h1chk:
s_waitcnt vmcnt(0)
v_xor_b32 v40, v20, v64
v_xor_b32 v41, v21, v65
v_or_b32 v40, v40, v41
v_xor_b32 v41, v19, v68
v_or_b32 v40, v40, v41
v_xor_b32 v41, v23, v69
v_or_b32 v40, v40, v41
v_xor_b32 v41, v24, v70
v_or_b32 v40, v40, v41
v_xor_b32 v41, v25, v71
v_or_b32 v40, v40, v41
v_and_b32 v40, 0xff, v40
v_cmp_ne_u32 vcc, 0, v40
s_cbranch_vccz L_h1polld
s_sub_u32 s69, s69, 1
s_cmp_eq_u32 s69, 0
s_cbranch_scc0 L_h1poll
L_h1polld:
v_and_b32 v68, v55, v68
v_mul_f32 v68, s79, v68
v_and_b32 v69, v55, v69
v_and_b32 v64, v55, v64
v_and_b32 v65, v55, v65
v_max_f32_dpp v40, v68, v68 row_ror:8 row_mask:0xf bank_mask:0xf
v_mov_b32 v41, v40
s_nop 1
v_permlane16_swap_b32 v40, v41
v_max_f32 v40, v40, v41
v_sub_f32 v68, v68, v40
v_exp_f32 v68, v68
s_nop 0
v_mul_f32 v69, v69, v68
v_mul_f32 v64, v64, v68
v_mul_f32 v65, v65, v68
s_nop 0
v_add_f32_dpp v69, v69, v69 row_ror:8 row_mask:0xf bank_mask:0xf
v_add_f32_dpp v64, v64, v64 row_ror:8 row_mask:0xf bank_mask:0xf
v_add_f32_dpp v65, v65, v65 row_ror:8 row_mask:0xf bank_mask:0xf
v_mov_b32 v41, v69
v_mov_b32 v42, v64
v_mov_b32 v43, v65
s_nop 0
v_permlane16_swap_b32 v69, v41
v_permlane16_swap_b32 v64, v42
v_permlane16_swap_b32 v65, v43
v_add_f32 v69, v69, v41
v_add_f32 v64, v64, v42
v_add_f32 v65, v65, v43
v_rcp_f32 v69, v69
s_nop 0
v_mul_f32 v64, v64, v69
v_mul_f32 v65, v65, v69
v_cvt_pk_bf16_f32 v44, v64, v65
ds_bpermute_b32 v40, v10, v44 offset:0
ds_bpermute_b32 v41, v10, v44 offset:16
s_waitcnt lgkmcnt(1)
v_perm_b32 v40, v40, v40, v12
v_and_b32 v80, v40, v14
v_and_b32 v81, v40, v15
s_waitcnt lgkmcnt(0)
v_perm_b32 v41, v41, v41, v12
v_and_b32 v82, v41, v14
v_and_b32 v83, v41, v15
s_nop 0
v_mfma_f32_16x16x16_bf16 v[96:99], v[192:193], v[80:81], 0
v_mfma_f32_16x16x16_bf16 v[100:103], v[194:195], v[80:81], 0
v_mfma_f32_16x16x16_bf16 v[96:99], v[196:197], v[82:83], v[96:99]
v_mfma_f32_16x16x16_bf16 v[100:103], v[198:199], v[82:83], v[100:103]
s_cmp_eq_u32 s82, 1
s_cbranch_scc0 L_ndAa
v_mfma_f32_16x16x16_bf16 v[112:115], v[212:213], v[80:81], 0
v_mfma_f32_16x16x16_bf16 v[116:119], v[214:215], v[80:81], 0
v_mfma_f32_16x16x16_bf16 v[112:115], v[216:217], v[82:83], v[112:115]
v_mfma_f32_16x16x16_bf16 v[116:119], v[218:219], v[82:83], v[116:119]
L_ndAa:
s_mov_b32 exec_lo, 0x00ff00ff
s_mov_b32 exec_hi, 0xff00ff00
s_nop 5
ds_write_b128 v13, v[96:99] offset:18048
ds_write_b128 v13, v[100:103] offset:18112
s_cbranch_scc0 L_ndAb
s_nop 1
ds_write_b128 v13, v[112:115] offset:34432
ds_write_b128 v13, v[116:119] offset:34496
L_ndAb:
s_mov_b64 exec, -1
s_waitcnt lgkmcnt(0)
s_barrier
s_cmp_gt_u32 s74, s82
s_cbranch_scc1 L_nopub
ds_read_b32 v64, v26 offset:18048
ds_read_b32 v65, v26 offset:19072
ds_read_b32 v66, v26 offset:20096
ds_read_b32 v67, v26 offset:21120
ds_read_b32 v68, v26 offset:22144
ds_read_b32 v69, v26 offset:23168
ds_read_b32 v70, v26 offset:24192
ds_read_b32 v71, v26 offset:25216
ds_read_b32 v72, v26 offset:26240
ds_read_b32 v73, v26 offset:27264
ds_read_b32 v74, v26 offset:28288
ds_read_b32 v75, v26 offset:29312
ds_read_b32 v76, v26 offset:30336
ds_read_b32 v77, v26 offset:31360
ds_read_b32 v78, v26 offset:32384
ds_read_b32 v79, v26 offset:33408
s_waitcnt lgkmcnt(0)
v_add_f32 v64, v64, v65
v_add_f32 v66, v66, v67
v_add_f32 v68, v68, v69
v_add_f32 v70, v70, v71
v_add_f32 v72, v72, v73
v_add_f32 v74, v74, v75
v_add_f32 v76, v76, v77
v_add_f32 v78, v78, v79
v_add_f32 v64, v64, v66
v_add_f32 v68, v68, v70
v_add_f32 v72, v72, v74
v_add_f32 v76, v76, v78
v_add_f32 v64, v64, v68
v_add_f32 v72, v72, v76
v_add_f32 v64, v64, v72
v_add_u32 v64, 0x80, v64
v_bfi_b32 v63, v3, v22, v64
buffer_store_dword v63, v17, s[36:39], s77 offen sc1
L_nopub:
s_cmp_ge_u32 s2, 18
s_cbranch_scc1 L_end
s_lshl_b32 s78, s2, 7
s_mov_b32 s48, s4
s_mov_b32 s49, s5
s_mov_b32 s50, 2304
s_mov_b32 s51, 0x20000
s_mov_b32 s52, s22
s_mov_b32 s53, s23
s_mov_b32 s54, 2304
s_mov_b32 s55, 0x20000
v_lshlrev_b32 v6, 1, v0
buffer_load_ushort v7, v6, s[48:51], s78 offen
s_lshl_b32 s77, s2, 5
s_lshl_b32 s74, s64, 2
s_add_u32 s77, s77, s74
s_lshl_b32 s77, s77, 9
s_add_u32 s77, s77, 589824
s_lshl_b32 s74, s64, 9
v_add_u32 v5, s74, v4
s_mov_b32 s69, 40000
L_h2poll:
buffer_load_dword v64, v17, s[36:39], s77 offen offset:0 sc1
buffer_load_dword v65, v17, s[36:39], s77 offen offset:256 sc1
buffer_load_dword v66, v17, s[36:39], s77 offen offset:512 sc1
buffer_load_dword v67, v17, s[36:39], s77 offen offset:768 sc1
buffer_load_dword v68, v17, s[36:39], s77 offen offset:1024 sc1
buffer_load_dword v69, v17, s[36:39], s77 offen offset:1280 sc1
buffer_load_dword v70, v17, s[36:39], s77 offen offset:1536 sc1
buffer_load_dword v71, v17, s[36:39], s77 offen offset:1792 sc1
s_waitcnt vmcnt(0)
v_xor_b32 v40, v22, v64
v_xor_b32 v41, v22, v65
v_or_b32 v40, v40, v41
v_xor_b32 v41, v22, v66
v_or_b32 v40, v40, v41
v_xor_b32 v41, v22, v67
v_or_b32 v40, v40, v41
v_xor_b32 v41, v22, v68
v_or_b32 v40, v40, v41
v_xor_b32 v41, v22, v69
v_or_b32 v40, v40, v41
v_xor_b32 v41, v22, v70
v_or_b32 v40, v40, v41
v_xor_b32 v41, v22, v71
v_or_b32 v40, v40, v41
v_and_b32 v40, 0xff, v40
v_cmp_ne_u32 vcc, 0, v40
s_cbranch_vccz L_h2polld
s_sub_u32 s69, s69, 1
s_cmp_eq_u32 s69, 0
s_cbranch_scc0 L_h2poll
L_h2polld:
v_and_b32 v64, v55, v64
v_and_b32 v65, v55, v65
v_and_b32 v66, v55, v66
v_and_b32 v67, v55, v67
v_and_b32 v68, v55, v68
v_and_b32 v69, v55, v69
v_and_b32 v70, v55, v70
v_and_b32 v71, v55, v71
v_add_f32 v64, v64, v66
v_add_f32 v68, v68, v70
v_add_f32 v64, v64, v68
v_add_f32 v65, v65, v67
v_add_f32 v69, v69, v71
v_add_f32 v65, v65, v69
ds_write_b64 v5, v[64:65] offset:13952
s_waitcnt lgkmcnt(0)
s_barrier
s_cmp_lg_u32 s64, 0
s_cbranch_scc1 L_end
ds_read_b64 v[64:65], v5 offset:13952
ds_read_b64 v[66:67], v5 offset:14464
ds_read_b64 v[68:69], v5 offset:14976
ds_read_b64 v[70:71], v5 offset:15488
ds_read_b64 v[72:73], v5 offset:16000
ds_read_b64 v[74:75], v5 offset:16512
ds_read_b64 v[76:77], v5 offset:17024
ds_read_b64 v[78:79], v5 offset:17536
v_lshlrev_b32 v7, 16, v7
s_waitcnt lgkmcnt(0)
v_add_f32 v64, v64, v66
v_add_f32 v65, v65, v67
v_add_f32 v68, v68, v70
v_add_f32 v69, v69, v71
v_add_f32 v72, v72, v74
v_add_f32 v73, v73, v75
v_add_f32 v76, v76, v78
v_add_f32 v77, v77, v79
v_add_f32 v64, v64, v68
v_add_f32 v65, v65, v69
v_add_f32 v72, v72, v76
v_add_f32 v73, v73, v77
v_add_f32 v64, v64, v72
v_add_f32 v65, v65, v73
v_cvt_pk_bf16_f32 v66, v64, v65
v_lshlrev_b32 v64, 16, v66
v_and_b32 v65, 0xffff0000, v66
v_add_f32 v64, v64, v7
v_cvt_pk_bf16_f32 v64, v64, v64
v_lshlrev_b32 v64, 16, v64
v_add_f32 v64, v64, v65
v_cvt_pk_bf16_f32 v64, v64, v64
buffer_store_short v64, v6, s[52:55], s78 offen
s_cmp_lg_u32 s2, 0
s_cbranch_scc1 L_nobump
s_mov_b64 exec, 1
buffer_store_dword v19, v18, s[36:39], 0 offen sc1
s_mov_b64 exec, -1
L_nobump:
L_end:
s_endpgm
.section .rodata,"a"
.p2align 6
.amdhsa_kernel parallel_sum__mha_block_cached__geglu_ffn__decode_kernel
  .amdhsa_next_free_vgpr 256
  .amdhsa_next_free_sgpr 102
  .amdhsa_accum_offset 256
  .amdhsa_group_segment_fixed_size 0
  .amdhsa_kernarg_size 96
  .amdhsa_user_sgpr_count 2
  .amdhsa_user_sgpr_kernarg_segment_ptr 1
  .amdhsa_system_sgpr_workgroup_id_x 1
.end_amdhsa_kernel
```
